```python
import torch

def _softmax(x, axis=-1):
    return torch.softmax(x, dim=axis)
def _gelu(x):
    return torch.nn.functional.gelu(x, approximate="tanh")
def _silu(x):
    return torch.nn.functional.silu(x)
def _sigmoid(x):
    return torch.sigmoid(x)
def _layernorm(x, axis=-1, eps=1e-5):
    m = x.mean(dim=axis, keepdim=True)
    v = x.var(dim=axis, keepdim=True, unbiased=False)
    return (x - m) / torch.sqrt(v + eps)
def _scatter_add(tgt, idx, src, axis=0):
    return tgt.clone().index_add_(axis, idx, src)
def _segment_sum(src, seg, n):
    out = torch.zeros((n,) + src.shape[1:], dtype=src.dtype)
    return out.index_add_(0, seg, src)
def _pad(x, pw):
    flat = tuple(v for pair in reversed(pw) for v in pair)
    return torch.nn.functional.pad(x, flat)

kernel_name = 'concat_heads__spectral_gfnet__ssm_conv_s4d__prompt'

def setup_inputs():

    _w = (lambda a: (lambda t: t.to(torch.bfloat16) if t.is_floating_point() else t)(torch.as_tensor(a)))
    def _A_setup():
        B, S, D = 1, 2048, 1024
        Df = D // 2 + 1
        return {
            "x": _w((lambda *s: torch.randn(*s, dtype=torch.bfloat16) * 0.05)(B, S, D)),
            "w_r": _w((lambda *s: torch.randn(*s, dtype=torch.bfloat16) * 0.8)(S, Df) * 0.02),
            "w_i": _w((lambda *s: torch.randn(*s, dtype=torch.bfloat16) * 0.8)(S, Df) * 0.02),
        }
    _A_in = _A_setup()

    def _B_setup():
        Bsz, L, D, N = 1, 2048, 1024, 128
        return {
            "u": _w((lambda *s: torch.randn(*s, dtype=torch.bfloat16) * 0.05)(Bsz, L, D)),
            "log_A_real": _w((lambda *s: torch.randn(*s, dtype=torch.bfloat16) * 6.4)(D, N) * 0.5),
            "A_imag": _w((lambda *s: torch.randn(*s, dtype=torch.bfloat16) * 0.05)(D, N) * 3.14),
            "C_real": _w((lambda *s: torch.randn(*s, dtype=torch.bfloat16) * 0.05)(D, N) / N ** 0.5),
            "C_imag": _w((lambda *s: torch.randn(*s, dtype=torch.bfloat16) * 0.05)(D, N) / N ** 0.5),
            "log_dt": _w((lambda *s: torch.randn(*s, dtype=torch.bfloat16) * 0.05)(D) * 0.5 - 4.0),
            "D_skip": _w((lambda *s: torch.randn(*s, dtype=torch.bfloat16) * 0.05)(D)),
        }
    _B_in = _B_setup()

    return {
        "A_x": _A_in["x"],
        "A_w_r": _A_in["w_r"],
        "A_w_i": _A_in["w_i"],
        "B_u": _B_in["u"],
        "B_log_A_real": _B_in["log_A_real"],
        "B_A_imag": _B_in["A_imag"],
        "B_C_real": _B_in["C_real"],
        "B_C_imag": _B_in["C_imag"],
        "B_log_dt": _B_in["log_dt"],
        "B_D_skip": _B_in["D_skip"],
    }

def reference(A_x, A_w_r, A_w_i, B_u, B_log_A_real, B_A_imag, B_C_real, B_C_imag, B_log_dt, B_D_skip):
    def _A_ref(x, w_r, w_i):
        B, S, D = x.shape
        X = (lambda x, axes=(-2,-1): torch.fft.rfft2(x.float(), dim=axes))(x, axes=(-2, -1))
        W = w_r + 1j * w_i
        X = X * W
        y = (lambda x, s, axes=(-2,-1): torch.fft.irfft2(x, s=s, dim=axes).to(torch.bfloat16))(X, (S, D), axes=(-2, -1))
        return y

    def _B_ref(u, log_A_real, A_imag, C_real, C_imag, log_dt, D_skip):
        L = u.shape[1]
        dt = torch.exp(log_dt)
        A = -torch.exp(log_A_real) + 1j * A_imag
        C = (C_real + 1j * C_imag) * dt[:, None]
        pos = (lambda x, dt: x.to(dt))(torch.arange(L), log_dt.dtype)
        P = torch.exp((A * dt[:, None])[:, :, None] * pos[None, None, :])
        K = 2.0 * torch.einsum("dn,dnl->dl", C, P).real
        L2 = 2 * L
        u_t = (lambda x, *d: x.permute(*d))(u, 0, 2, 1)
        Kf = (lambda x, *a, **k: torch.fft.rfft(x.float(), *a, **k))(K, L2)
        Uf = (lambda x, *a, **k: torch.fft.rfft(x.float(), *a, **k))(u_t, L2)
        y = (lambda x, *a, **k: torch.fft.irfft(x, *a, **k).to(torch.bfloat16))(Uf * Kf[None, :, :], L2)[:, :, :L]
        y = (lambda x, *d: x.permute(*d))(y, 0, 2, 1)
        return y + u * D_skip[None, None, :]

    a = _A_ref(A_x, A_w_r, A_w_i)
    b = _B_ref(B_u, B_log_A_real, B_A_imag, B_C_real, B_C_imag, B_log_dt, B_D_skip)
    return torch.concatenate([a, b], axis=-1)
```

```asm
; @launch kernel=k1_kernel grid=(1312,1,1) block=(256,1,1) lds=25856
; @launch kernel=k2_kernel grid=(768,1,1) block=(256,1,1) lds=48672
; @launch kernel=k3_kernel grid=(512,1,1) block=(256,1,1) lds=41856
.amdgcn_target "amdgcn-amd-amdhsa--gfx950"
.text
.globl k1_kernel
.p2align 8
.type k1_kernel,@function
k1_kernel:
    s_mov_b32 s94, s2
    s_cmp_lt_u32 s2, 256
    s_cbranch_scc1 L_k1_kernel_r0
    s_sub_u32 s2, s2, 256
    s_cmp_lt_u32 s2, 512
    s_cbranch_scc1 L_k1_kernel_r1
    s_sub_u32 s2, s2, 512
    s_cmp_lt_u32 s2, 288
    s_cbranch_scc1 L_k1_kernel_r2
    s_sub_u32 s2, s2, 288
    s_cmp_lt_u32 s2, 256
    s_cbranch_scc1 L_k1_kernel_r3
    s_sub_u32 s2, s2, 256
    s_endpgm
.p2align 6
L_k1_kernel_r0:
    s_mov_b32 s57, 67108864
    s_load_dwordx2 s[4:5], s[0:1], 0
    s_load_dwordx2 s[28:29], s[0:1], 96
    s_mov_b32 s20, 0x3f6c835e
    s_mov_b32 s21, 0xbec3ef15
    s_mov_b32 s22, 0x3f3504f3
    s_mov_b32 s23, 0xbf3504f3
    s_mov_b32 s24, 0x3ec3ef15
    s_mov_b32 s25, 0xbf6c835e
    v_lshrrev_b32 v5, 6, v0
    s_nop 0
    v_readfirstlane_b32 s30, v5
    v_and_b32 v6, 63, v0
    s_lshl_b32 s16, s2, 3
    s_lshl_b32 s17, s30, 1
    s_add_u32 s17, s17, s16
    s_lshl_b32 s17, s17, 11
    s_add_u32 s18, s17, 2048
    v_lshlrev_b32 v7, 2, v6
    s_waitcnt lgkmcnt(0)
    s_mov_b32 s8, s4
    s_mov_b32 s9, s5
    s_mov_b32 s10, 4194304
    s_mov_b32 s11, 0x00020000
    s_mov_b32 s32, s28
    s_mov_b32 s33, s29
    s_mov_b32 s34, 268435456
    s_mov_b32 s35, 0x00020000
    buffer_load_dword v76, v7, s[8:11], s17 offen offset:0
    buffer_load_dword v77, v7, s[8:11], s17 offen offset:256
    buffer_load_dword v78, v7, s[8:11], s17 offen offset:512
    buffer_load_dword v79, v7, s[8:11], s17 offen offset:768
    buffer_load_dword v80, v7, s[8:11], s17 offen offset:1024
    buffer_load_dword v81, v7, s[8:11], s17 offen offset:1280
    buffer_load_dword v82, v7, s[8:11], s17 offen offset:1536
    buffer_load_dword v83, v7, s[8:11], s17 offen offset:1792
    buffer_load_dword v84, v7, s[8:11], s18 offen offset:0
    buffer_load_dword v85, v7, s[8:11], s18 offen offset:256
    buffer_load_dword v86, v7, s[8:11], s18 offen offset:512
    buffer_load_dword v87, v7, s[8:11], s18 offen offset:768
    buffer_load_dword v88, v7, s[8:11], s18 offen offset:1024
    buffer_load_dword v89, v7, s[8:11], s18 offen offset:1280
    buffer_load_dword v90, v7, s[8:11], s18 offen offset:1536
    buffer_load_dword v91, v7, s[8:11], s18 offen offset:1792
    v_cvt_f32_u32 v10, v6
    v_mul_f32 v11, 0x3b000000, v10
    v_cos_f32 v48, v11
    v_sin_f32_e64 v49, -v11
    v_mul_f32 v51, 0x40000000, v11
    v_cos_f32 v50, v51
    v_sin_f32_e64 v51, -v51
    v_mul_f32 v53, 0x40400000, v11
    v_cos_f32 v52, v53
    v_sin_f32_e64 v53, -v53
    v_mul_f32 v55, 0x40800000, v11
    v_cos_f32 v54, v55
    v_sin_f32_e64 v55, -v55
    v_mul_f32 v57, 0x40a00000, v11
    v_cos_f32 v56, v57
    v_sin_f32_e64 v57, -v57
    v_mul_f32 v59, 0x40c00000, v11
    v_cos_f32 v58, v59
    v_sin_f32_e64 v59, -v59
    v_mul_f32 v61, 0x40e00000, v11
    v_cos_f32 v60, v61
    v_sin_f32_e64 v61, -v61
    v_and_b32 v12, 7, v6
    v_lshrrev_b32 v13, 3, v6
    v_cvt_f32_u32 v14, v12
    v_mul_f32 v15, 0x3c800000, v14
    v_cos_f32 v62, v15
    v_sin_f32_e64 v63, -v15
    v_mul_f32 v65, 0x40000000, v15
    v_cos_f32 v64, v65
    v_sin_f32_e64 v65, -v65
    v_mul_f32 v67, 0x40400000, v15
    v_cos_f32 v66, v67
    v_sin_f32_e64 v67, -v67
    v_mul_f32 v69, 0x40800000, v15
    v_cos_f32 v68, v69
    v_sin_f32_e64 v69, -v69
    v_mul_f32 v71, 0x40a00000, v15
    v_cos_f32 v70, v71
    v_sin_f32_e64 v71, -v71
    v_mul_f32 v73, 0x40c00000, v15
    v_cos_f32 v72, v73
    v_sin_f32_e64 v73, -v73
    v_mul_f32 v75, 0x40e00000, v15
    v_cos_f32 v74, v75
    v_sin_f32_e64 v75, -v75
    s_mul_i32 s40, s30, 5232
    v_lshlrev_b32 v16, 3, v6
    v_mul_u32_u24 v17, 72, v13
    v_add_u32 v17, v17, v12
    v_lshlrev_b32 v17, 3, v17
    v_mul_u32_u24 v18, 10, v13
    v_add_u32 v18, v18, v12
    v_lshlrev_b32 v18, 3, v18
    v_mul_u32_u24 v19, 80, v6
    v_add_u32 v22, s40, v16
    v_add_u32 v23, s40, v17
    v_add_u32 v24, s40, v18
    v_add_u32 v25, s40, v19
    v_lshrrev_b32 v30, 2, v6
    v_mul_u32_u24 v30, 144, v30
    v_and_b32 v31, 3, v6
    v_lshl_add_u32 v30, v31, 2, v30
    s_lshl_b32 s42, s30, 5
    v_add_u32 v30, s42, v30
    v_and_b32 v1, 7, v0
    v_lshrrev_b32 v2, 3, v0
    v_mul_u32_u24 v4, 144, v2
    v_lshl_add_u32 v4, v1, 4, v4
    v_mul_u32_u24 v3, 32768, v2
    v_lshl_add_u32 v3, v1, 4, v3
    s_waitcnt vmcnt(8)
    v_lshlrev_b32 v32, 16, v76
    v_and_b32 v33, 0xffff0000, v76
    v_lshlrev_b32 v34, 16, v77
    v_and_b32 v35, 0xffff0000, v77
    v_lshlrev_b32 v36, 16, v78
    v_and_b32 v37, 0xffff0000, v78
    v_lshlrev_b32 v38, 16, v79
    v_and_b32 v39, 0xffff0000, v79
    v_lshlrev_b32 v40, 16, v80
    v_and_b32 v41, 0xffff0000, v80
    v_lshlrev_b32 v42, 16, v81
    v_and_b32 v43, 0xffff0000, v81
    v_lshlrev_b32 v44, 16, v82
    v_and_b32 v45, 0xffff0000, v82
    v_lshlrev_b32 v46, 16, v83
    v_and_b32 v47, 0xffff0000, v83
    v_pk_add_f32 v[92:93], v[32:33], v[40:41] neg_lo:[0,1] neg_hi:[0,1]
    v_pk_add_f32 v[32:33], v[32:33], v[40:41]
    v_pk_add_f32 v[94:95], v[34:35], v[42:43] neg_lo:[0,1] neg_hi:[0,1]
    v_pk_add_f32 v[34:35], v[34:35], v[42:43]
    v_pk_mul_f32 v[40:41], v[94:95], s[22:23] op_sel:[0,0] op_sel_hi:[1,0]
    v_pk_fma_f32 v[94:95], v[94:95], s[22:23], v[40:41] op_sel:[1,1,0] op_sel_hi:[0,1,1] neg_lo:[0,1,0]
    v_pk_add_f32 v[42:43], v[36:37], v[44:45] neg_lo:[0,1] neg_hi:[0,1]
    v_pk_add_f32 v[36:37], v[36:37], v[44:45]
    v_pk_add_f32 v[40:41], v[38:39], v[46:47] neg_lo:[0,1] neg_hi:[0,1]
    v_pk_add_f32 v[38:39], v[38:39], v[46:47]
    v_pk_mul_f32 v[44:45], v[40:41], s[22:23] op_sel:[0,0] op_sel_hi:[1,0]
    v_pk_fma_f32 v[40:41], v[40:41], s[22:23], v[44:45] op_sel:[1,1,0] op_sel_hi:[0,1,1] neg_lo:[0,1,0]
    v_pk_add_f32 v[46:47], v[32:33], v[36:37] neg_lo:[0,1] neg_hi:[0,1]
    v_pk_add_f32 v[32:33], v[32:33], v[36:37]
    v_pk_add_f32 v[36:37], v[34:35], v[38:39] neg_lo:[0,1] neg_hi:[0,1]
    v_pk_add_f32 v[34:35], v[34:35], v[38:39]
    v_pk_add_f32 v[38:39], v[32:33], v[34:35] neg_lo:[0,1] neg_hi:[0,1]
    v_pk_add_f32 v[32:33], v[32:33], v[34:35]
    v_pk_add_f32 v[34:35], v[46:47], v[36:37] op_sel:[0,1] op_sel_hi:[1,0] neg_hi:[0,1]
    v_pk_add_f32 v[46:47], v[46:47], v[36:37] op_sel:[0,1] op_sel_hi:[1,0] neg_lo:[0,1]
    v_pk_add_f32 v[44:45], v[92:93], v[42:43] op_sel:[0,1] op_sel_hi:[1,0] neg_lo:[0,1]
    v_pk_add_f32 v[92:93], v[92:93], v[42:43] op_sel:[0,1] op_sel_hi:[1,0] neg_hi:[0,1]
    v_pk_add_f32 v[42:43], v[94:95], v[40:41] op_sel:[0,1] op_sel_hi:[1,0] neg_lo:[0,1]
    v_pk_add_f32 v[94:95], v[94:95], v[40:41] op_sel:[0,1] op_sel_hi:[1,0] neg_hi:[0,1]
    v_pk_add_f32 v[40:41], v[92:93], v[94:95] neg_lo:[0,1] neg_hi:[0,1]
    v_pk_add_f32 v[92:93], v[92:93], v[94:95]
    v_pk_add_f32 v[94:95], v[44:45], v[42:43] op_sel:[0,1] op_sel_hi:[1,0] neg_hi:[0,1]
    v_pk_add_f32 v[44:45], v[44:45], v[42:43] op_sel:[0,1] op_sel_hi:[1,0] neg_lo:[0,1]
    ds_write_b64 v22, v[32:33] offset:0
    v_pk_mul_f32 v[36:37], v[92:93], v[48:49] op_sel:[0,0] op_sel_hi:[1,0]
    v_pk_fma_f32 v[92:93], v[92:93], v[48:49], v[36:37] op_sel:[1,1,0] op_sel_hi:[0,1,1] neg_lo:[0,1,0]
    ds_write_b64 v22, v[92:93] offset:576
    v_pk_mul_f32 v[42:43], v[34:35], v[50:51] op_sel:[0,0] op_sel_hi:[1,0]
    v_pk_fma_f32 v[34:35], v[34:35], v[50:51], v[42:43] op_sel:[1,1,0] op_sel_hi:[0,1,1] neg_lo:[0,1,0]
    ds_write_b64 v22, v[34:35] offset:1152
    v_pk_mul_f32 v[32:33], v[94:95], v[52:53] op_sel:[0,0] op_sel_hi:[1,0]
    v_pk_fma_f32 v[94:95], v[94:95], v[52:53], v[32:33] op_sel:[1,1,0] op_sel_hi:[0,1,1] neg_lo:[0,1,0]
    ds_write_b64 v22, v[94:95] offset:1728
    v_pk_mul_f32 v[36:37], v[38:39], v[54:55] op_sel:[0,0] op_sel_hi:[1,0]
    v_pk_fma_f32 v[38:39], v[38:39], v[54:55], v[36:37] op_sel:[1,1,0] op_sel_hi:[0,1,1] neg_lo:[0,1,0]
    ds_write_b64 v22, v[38:39] offset:2304
    v_pk_mul_f32 v[92:93], v[40:41], v[56:57] op_sel:[0,0] op_sel_hi:[1,0]
    v_pk_fma_f32 v[40:41], v[40:41], v[56:57], v[92:93] op_sel:[1,1,0] op_sel_hi:[0,1,1] neg_lo:[0,1,0]
    ds_write_b64 v22, v[40:41] offset:2880
    v_pk_mul_f32 v[42:43], v[46:47], v[58:59] op_sel:[0,0] op_sel_hi:[1,0]
    v_pk_fma_f32 v[46:47], v[46:47], v[58:59], v[42:43] op_sel:[1,1,0] op_sel_hi:[0,1,1] neg_lo:[0,1,0]
    ds_write_b64 v22, v[46:47] offset:3456
    v_pk_mul_f32 v[34:35], v[44:45], v[60:61] op_sel:[0,0] op_sel_hi:[1,0]
    v_pk_fma_f32 v[44:45], v[44:45], v[60:61], v[34:35] op_sel:[1,1,0] op_sel_hi:[0,1,1] neg_lo:[0,1,0]
    ds_write_b64 v22, v[44:45] offset:4032
    ds_read_b64 v[32:33], v23 offset:0
    ds_read_b64 v[94:95], v23 offset:64
    ds_read_b64 v[36:37], v23 offset:128
    ds_read_b64 v[38:39], v23 offset:192
    ds_read_b64 v[92:93], v23 offset:256
    ds_read_b64 v[40:41], v23 offset:320
    ds_read_b64 v[42:43], v23 offset:384
    ds_read_b64 v[46:47], v23 offset:448
    s_waitcnt lgkmcnt(0)
    v_pk_add_f32 v[34:35], v[32:33], v[92:93] neg_lo:[0,1] neg_hi:[0,1]
    v_pk_add_f32 v[32:33], v[32:33], v[92:93]
    v_pk_add_f32 v[44:45], v[94:95], v[40:41] neg_lo:[0,1] neg_hi:[0,1]
    v_pk_add_f32 v[94:95], v[94:95], v[40:41]
    v_pk_mul_f32 v[92:93], v[44:45], s[22:23] op_sel:[0,0] op_sel_hi:[1,0]
    v_pk_fma_f32 v[44:45], v[44:45], s[22:23], v[92:93] op_sel:[1,1,0] op_sel_hi:[0,1,1] neg_lo:[0,1,0]
    v_pk_add_f32 v[40:41], v[36:37], v[42:43] neg_lo:[0,1] neg_hi:[0,1]
    v_pk_add_f32 v[36:37], v[36:37], v[42:43]
    v_pk_add_f32 v[92:93], v[38:39], v[46:47] neg_lo:[0,1] neg_hi:[0,1]
    v_pk_add_f32 v[38:39], v[38:39], v[46:47]
    v_pk_mul_f32 v[42:43], v[92:93], s[22:23] op_sel:[0,0] op_sel_hi:[1,0]
    v_pk_fma_f32 v[92:93], v[92:93], s[22:23], v[42:43] op_sel:[1,1,0] op_sel_hi:[0,1,1] neg_lo:[0,1,0]
    v_pk_add_f32 v[46:47], v[32:33], v[36:37] neg_lo:[0,1] neg_hi:[0,1]
    v_pk_add_f32 v[32:33], v[32:33], v[36:37]
    v_pk_add_f32 v[36:37], v[94:95], v[38:39] neg_lo:[0,1] neg_hi:[0,1]
    v_pk_add_f32 v[94:95], v[94:95], v[38:39]
    v_pk_add_f32 v[38:39], v[32:33], v[94:95] neg_lo:[0,1] neg_hi:[0,1]
    v_pk_add_f32 v[32:33], v[32:33], v[94:95]
    v_pk_add_f32 v[94:95], v[46:47], v[36:37] op_sel:[0,1] op_sel_hi:[1,0] neg_hi:[0,1]
    v_pk_add_f32 v[46:47], v[46:47], v[36:37] op_sel:[0,1] op_sel_hi:[1,0] neg_lo:[0,1]
    v_pk_add_f32 v[42:43], v[34:35], v[40:41] op_sel:[0,1] op_sel_hi:[1,0] neg_lo:[0,1]
    v_pk_add_f32 v[34:35], v[34:35], v[40:41] op_sel:[0,1] op_sel_hi:[1,0] neg_hi:[0,1]
    v_pk_add_f32 v[40:41], v[44:45], v[92:93] op_sel:[0,1] op_sel_hi:[1,0] neg_lo:[0,1]
    v_pk_add_f32 v[44:45], v[44:45], v[92:93] op_sel:[0,1] op_sel_hi:[1,0] neg_hi:[0,1]
    v_pk_add_f32 v[92:93], v[34:35], v[44:45] neg_lo:[0,1] neg_hi:[0,1]
    v_pk_add_f32 v[34:35], v[34:35], v[44:45]
    v_pk_add_f32 v[44:45], v[42:43], v[40:41] op_sel:[0,1] op_sel_hi:[1,0] neg_hi:[0,1]
    v_pk_add_f32 v[42:43], v[42:43], v[40:41] op_sel:[0,1] op_sel_hi:[1,0] neg_lo:[0,1]
    ds_write_b64 v24, v[32:33] offset:0
    v_pk_mul_f32 v[36:37], v[34:35], v[62:63] op_sel:[0,0] op_sel_hi:[1,0]
    v_pk_fma_f32 v[34:35], v[34:35], v[62:63], v[36:37] op_sel:[1,1,0] op_sel_hi:[0,1,1] neg_lo:[0,1,0]
    ds_write_b64 v24, v[34:35] offset:640
    v_pk_mul_f32 v[40:41], v[94:95], v[64:65] op_sel:[0,0] op_sel_hi:[1,0]
    v_pk_fma_f32 v[94:95], v[94:95], v[64:65], v[40:41] op_sel:[1,1,0] op_sel_hi:[0,1,1] neg_lo:[0,1,0]
    ds_write_b64 v24, v[94:95] offset:1280
    v_pk_mul_f32 v[32:33], v[44:45], v[66:67] op_sel:[0,0] op_sel_hi:[1,0]
    v_pk_fma_f32 v[44:45], v[44:45], v[66:67], v[32:33] op_sel:[1,1,0] op_sel_hi:[0,1,1] neg_lo:[0,1,0]
    ds_write_b64 v24, v[44:45] offset:1920
    v_pk_mul_f32 v[36:37], v[38:39], v[68:69] op_sel:[0,0] op_sel_hi:[1,0]
    v_pk_fma_f32 v[38:39], v[38:39], v[68:69], v[36:37] op_sel:[1,1,0] op_sel_hi:[0,1,1] neg_lo:[0,1,0]
    ds_write_b64 v24, v[38:39] offset:2560
    v_pk_mul_f32 v[34:35], v[92:93], v[70:71] op_sel:[0,0] op_sel_hi:[1,0]
    v_pk_fma_f32 v[92:93], v[92:93], v[70:71], v[34:35] op_sel:[1,1,0] op_sel_hi:[0,1,1] neg_lo:[0,1,0]
    ds_write_b64 v24, v[92:93] offset:3200
    v_pk_mul_f32 v[40:41], v[46:47], v[72:73] op_sel:[0,0] op_sel_hi:[1,0]
    v_pk_fma_f32 v[46:47], v[46:47], v[72:73], v[40:41] op_sel:[1,1,0] op_sel_hi:[0,1,1] neg_lo:[0,1,0]
    ds_write_b64 v24, v[46:47] offset:3840
    v_pk_mul_f32 v[94:95], v[42:43], v[74:75] op_sel:[0,0] op_sel_hi:[1,0]
    v_pk_fma_f32 v[42:43], v[42:43], v[74:75], v[94:95] op_sel:[1,1,0] op_sel_hi:[0,1,1] neg_lo:[0,1,0]
    ds_write_b64 v24, v[42:43] offset:4480
    ds_read_b128 v[32:35], v25 offset:0
    ds_read_b128 v[36:39], v25 offset:16
    ds_read_b128 v[40:43], v25 offset:32
    ds_read_b128 v[44:47], v25 offset:48
    s_waitcnt lgkmcnt(0)
    v_pk_add_f32 v[92:93], v[32:33], v[40:41] neg_lo:[0,1] neg_hi:[0,1]
    v_pk_add_f32 v[32:33], v[32:33], v[40:41]
    v_pk_add_f32 v[94:95], v[34:35], v[42:43] neg_lo:[0,1] neg_hi:[0,1]
    v_pk_add_f32 v[34:35], v[34:35], v[42:43]
    v_pk_mul_f32 v[40:41], v[94:95], s[22:23] op_sel:[0,0] op_sel_hi:[1,0]
    v_pk_fma_f32 v[94:95], v[94:95], s[22:23], v[40:41] op_sel:[1,1,0] op_sel_hi:[0,1,1] neg_lo:[0,1,0]
    v_pk_add_f32 v[42:43], v[36:37], v[44:45] neg_lo:[0,1] neg_hi:[0,1]
    v_pk_add_f32 v[36:37], v[36:37], v[44:45]
    v_pk_add_f32 v[40:41], v[38:39], v[46:47] neg_lo:[0,1] neg_hi:[0,1]
    v_pk_add_f32 v[38:39], v[38:39], v[46:47]
    v_pk_mul_f32 v[44:45], v[40:41], s[22:23] op_sel:[0,0] op_sel_hi:[1,0]
    v_pk_fma_f32 v[40:41], v[40:41], s[22:23], v[44:45] op_sel:[1,1,0] op_sel_hi:[0,1,1] neg_lo:[0,1,0]
    v_pk_add_f32 v[46:47], v[32:33], v[36:37] neg_lo:[0,1] neg_hi:[0,1]
    v_pk_add_f32 v[32:33], v[32:33], v[36:37]
    v_pk_add_f32 v[36:37], v[34:35], v[38:39] neg_lo:[0,1] neg_hi:[0,1]
    v_pk_add_f32 v[34:35], v[34:35], v[38:39]
    v_pk_add_f32 v[38:39], v[32:33], v[34:35] neg_lo:[0,1] neg_hi:[0,1]
    v_pk_add_f32 v[32:33], v[32:33], v[34:35]
    v_pk_add_f32 v[34:35], v[46:47], v[36:37] op_sel:[0,1] op_sel_hi:[1,0] neg_hi:[0,1]
    v_pk_add_f32 v[46:47], v[46:47], v[36:37] op_sel:[0,1] op_sel_hi:[1,0] neg_lo:[0,1]
    v_pk_add_f32 v[44:45], v[92:93], v[42:43] op_sel:[0,1] op_sel_hi:[1,0] neg_lo:[0,1]
    v_pk_add_f32 v[92:93], v[92:93], v[42:43] op_sel:[0,1] op_sel_hi:[1,0] neg_hi:[0,1]
    v_pk_add_f32 v[42:43], v[94:95], v[40:41] op_sel:[0,1] op_sel_hi:[1,0] neg_lo:[0,1]
    v_pk_add_f32 v[94:95], v[94:95], v[40:41] op_sel:[0,1] op_sel_hi:[1,0] neg_hi:[0,1]
    v_pk_add_f32 v[40:41], v[92:93], v[94:95] neg_lo:[0,1] neg_hi:[0,1]
    v_pk_add_f32 v[92:93], v[92:93], v[94:95]
    v_pk_add_f32 v[94:95], v[44:45], v[42:43] op_sel:[0,1] op_sel_hi:[1,0] neg_hi:[0,1]
    v_pk_add_f32 v[44:45], v[44:45], v[42:43] op_sel:[0,1] op_sel_hi:[1,0] neg_lo:[0,1]
    v_cvt_pk_bf16_f32 v76, v32, v33
    v_cvt_pk_bf16_f32 v77, v92, v93
    v_cvt_pk_bf16_f32 v78, v34, v35
    v_cvt_pk_bf16_f32 v79, v94, v95
    v_cvt_pk_bf16_f32 v80, v38, v39
    v_cvt_pk_bf16_f32 v81, v40, v41
    v_cvt_pk_bf16_f32 v82, v46, v47
    v_cvt_pk_bf16_f32 v83, v44, v45
    s_waitcnt vmcnt(0)
    v_lshlrev_b32 v32, 16, v84
    v_and_b32 v33, 0xffff0000, v84
    v_lshlrev_b32 v34, 16, v85
    v_and_b32 v35, 0xffff0000, v85
    v_lshlrev_b32 v36, 16, v86
    v_and_b32 v37, 0xffff0000, v86
    v_lshlrev_b32 v38, 16, v87
    v_and_b32 v39, 0xffff0000, v87
    v_lshlrev_b32 v40, 16, v88
    v_and_b32 v41, 0xffff0000, v88
    v_lshlrev_b32 v42, 16, v89
    v_and_b32 v43, 0xffff0000, v89
    v_lshlrev_b32 v44, 16, v90
    v_and_b32 v45, 0xffff0000, v90
    v_lshlrev_b32 v46, 16, v91
    v_and_b32 v47, 0xffff0000, v91
    v_pk_add_f32 v[92:93], v[32:33], v[40:41] neg_lo:[0,1] neg_hi:[0,1]
    v_pk_add_f32 v[32:33], v[32:33], v[40:41]
    v_pk_add_f32 v[94:95], v[34:35], v[42:43] neg_lo:[0,1] neg_hi:[0,1]
    v_pk_add_f32 v[34:35], v[34:35], v[42:43]
    v_pk_mul_f32 v[40:41], v[94:95], s[22:23] op_sel:[0,0] op_sel_hi:[1,0]
    v_pk_fma_f32 v[94:95], v[94:95], s[22:23], v[40:41] op_sel:[1,1,0] op_sel_hi:[0,1,1] neg_lo:[0,1,0]
    v_pk_add_f32 v[42:43], v[36:37], v[44:45] neg_lo:[0,1] neg_hi:[0,1]
    v_pk_add_f32 v[36:37], v[36:37], v[44:45]
    v_pk_add_f32 v[40:41], v[38:39], v[46:47] neg_lo:[0,1] neg_hi:[0,1]
    v_pk_add_f32 v[38:39], v[38:39], v[46:47]
    v_pk_mul_f32 v[44:45], v[40:41], s[22:23] op_sel:[0,0] op_sel_hi:[1,0]
    v_pk_fma_f32 v[40:41], v[40:41], s[22:23], v[44:45] op_sel:[1,1,0] op_sel_hi:[0,1,1] neg_lo:[0,1,0]
    v_pk_add_f32 v[46:47], v[32:33], v[36:37] neg_lo:[0,1] neg_hi:[0,1]
    v_pk_add_f32 v[32:33], v[32:33], v[36:37]
    v_pk_add_f32 v[36:37], v[34:35], v[38:39] neg_lo:[0,1] neg_hi:[0,1]
    v_pk_add_f32 v[34:35], v[34:35], v[38:39]
    v_pk_add_f32 v[38:39], v[32:33], v[34:35] neg_lo:[0,1] neg_hi:[0,1]
    v_pk_add_f32 v[32:33], v[32:33], v[34:35]
    v_pk_add_f32 v[34:35], v[46:47], v[36:37] op_sel:[0,1] op_sel_hi:[1,0] neg_hi:[0,1]
    v_pk_add_f32 v[46:47], v[46:47], v[36:37] op_sel:[0,1] op_sel_hi:[1,0] neg_lo:[0,1]
    v_pk_add_f32 v[44:45], v[92:93], v[42:43] op_sel:[0,1] op_sel_hi:[1,0] neg_lo:[0,1]
    v_pk_add_f32 v[92:93], v[92:93], v[42:43] op_sel:[0,1] op_sel_hi:[1,0] neg_hi:[0,1]
    v_pk_add_f32 v[42:43], v[94:95], v[40:41] op_sel:[0,1] op_sel_hi:[1,0] neg_lo:[0,1]
    v_pk_add_f32 v[94:95], v[94:95], v[40:41] op_sel:[0,1] op_sel_hi:[1,0] neg_hi:[0,1]
    v_pk_add_f32 v[40:41], v[92:93], v[94:95] neg_lo:[0,1] neg_hi:[0,1]
    v_pk_add_f32 v[92:93], v[92:93], v[94:95]
    v_pk_add_f32 v[94:95], v[44:45], v[42:43] op_sel:[0,1] op_sel_hi:[1,0] neg_hi:[0,1]
    v_pk_add_f32 v[44:45], v[44:45], v[42:43] op_sel:[0,1] op_sel_hi:[1,0] neg_lo:[0,1]
    ds_write_b64 v22, v[32:33] offset:0
    v_pk_mul_f32 v[36:37], v[92:93], v[48:49] op_sel:[0,0] op_sel_hi:[1,0]
    v_pk_fma_f32 v[92:93], v[92:93], v[48:49], v[36:37] op_sel:[1,1,0] op_sel_hi:[0,1,1] neg_lo:[0,1,0]
    ds_write_b64 v22, v[92:93] offset:576
    v_pk_mul_f32 v[42:43], v[34:35], v[50:51] op_sel:[0,0] op_sel_hi:[1,0]
    v_pk_fma_f32 v[34:35], v[34:35], v[50:51], v[42:43] op_sel:[1,1,0] op_sel_hi:[0,1,1] neg_lo:[0,1,0]
    ds_write_b64 v22, v[34:35] offset:1152
    v_pk_mul_f32 v[32:33], v[94:95], v[52:53] op_sel:[0,0] op_sel_hi:[1,0]
    v_pk_fma_f32 v[94:95], v[94:95], v[52:53], v[32:33] op_sel:[1,1,0] op_sel_hi:[0,1,1] neg_lo:[0,1,0]
    ds_write_b64 v22, v[94:95] offset:1728
    v_pk_mul_f32 v[36:37], v[38:39], v[54:55] op_sel:[0,0] op_sel_hi:[1,0]
    v_pk_fma_f32 v[38:39], v[38:39], v[54:55], v[36:37] op_sel:[1,1,0] op_sel_hi:[0,1,1] neg_lo:[0,1,0]
    ds_write_b64 v22, v[38:39] offset:2304
    v_pk_mul_f32 v[92:93], v[40:41], v[56:57] op_sel:[0,0] op_sel_hi:[1,0]
    v_pk_fma_f32 v[40:41], v[40:41], v[56:57], v[92:93] op_sel:[1,1,0] op_sel_hi:[0,1,1] neg_lo:[0,1,0]
    ds_write_b64 v22, v[40:41] offset:2880
    v_pk_mul_f32 v[42:43], v[46:47], v[58:59] op_sel:[0,0] op_sel_hi:[1,0]
    v_pk_fma_f32 v[46:47], v[46:47], v[58:59], v[42:43] op_sel:[1,1,0] op_sel_hi:[0,1,1] neg_lo:[0,1,0]
    ds_write_b64 v22, v[46:47] offset:3456
    v_pk_mul_f32 v[34:35], v[44:45], v[60:61] op_sel:[0,0] op_sel_hi:[1,0]
    v_pk_fma_f32 v[44:45], v[44:45], v[60:61], v[34:35] op_sel:[1,1,0] op_sel_hi:[0,1,1] neg_lo:[0,1,0]
    ds_write_b64 v22, v[44:45] offset:4032
    ds_read_b64 v[32:33], v23 offset:0
    ds_read_b64 v[94:95], v23 offset:64
    ds_read_b64 v[36:37], v23 offset:128
    ds_read_b64 v[38:39], v23 offset:192
    ds_read_b64 v[92:93], v23 offset:256
    ds_read_b64 v[40:41], v23 offset:320
    ds_read_b64 v[42:43], v23 offset:384
    ds_read_b64 v[46:47], v23 offset:448
    s_waitcnt lgkmcnt(0)
    v_pk_add_f32 v[34:35], v[32:33], v[92:93] neg_lo:[0,1] neg_hi:[0,1]
    v_pk_add_f32 v[32:33], v[32:33], v[92:93]
    v_pk_add_f32 v[44:45], v[94:95], v[40:41] neg_lo:[0,1] neg_hi:[0,1]
    v_pk_add_f32 v[94:95], v[94:95], v[40:41]
    v_pk_mul_f32 v[92:93], v[44:45], s[22:23] op_sel:[0,0] op_sel_hi:[1,0]
    v_pk_fma_f32 v[44:45], v[44:45], s[22:23], v[92:93] op_sel:[1,1,0] op_sel_hi:[0,1,1] neg_lo:[0,1,0]
    v_pk_add_f32 v[40:41], v[36:37], v[42:43] neg_lo:[0,1] neg_hi:[0,1]
    v_pk_add_f32 v[36:37], v[36:37], v[42:43]
    v_pk_add_f32 v[92:93], v[38:39], v[46:47] neg_lo:[0,1] neg_hi:[0,1]
    v_pk_add_f32 v[38:39], v[38:39], v[46:47]
    v_pk_mul_f32 v[42:43], v[92:93], s[22:23] op_sel:[0,0] op_sel_hi:[1,0]
    v_pk_fma_f32 v[92:93], v[92:93], s[22:23], v[42:43] op_sel:[1,1,0] op_sel_hi:[0,1,1] neg_lo:[0,1,0]
    v_pk_add_f32 v[46:47], v[32:33], v[36:37] neg_lo:[0,1] neg_hi:[0,1]
    v_pk_add_f32 v[32:33], v[32:33], v[36:37]
    v_pk_add_f32 v[36:37], v[94:95], v[38:39] neg_lo:[0,1] neg_hi:[0,1]
    v_pk_add_f32 v[94:95], v[94:95], v[38:39]
    v_pk_add_f32 v[38:39], v[32:33], v[94:95] neg_lo:[0,1] neg_hi:[0,1]
    v_pk_add_f32 v[32:33], v[32:33], v[94:95]
    v_pk_add_f32 v[94:95], v[46:47], v[36:37] op_sel:[0,1] op_sel_hi:[1,0] neg_hi:[0,1]
    v_pk_add_f32 v[46:47], v[46:47], v[36:37] op_sel:[0,1] op_sel_hi:[1,0] neg_lo:[0,1]
    v_pk_add_f32 v[42:43], v[34:35], v[40:41] op_sel:[0,1] op_sel_hi:[1,0] neg_lo:[0,1]
    v_pk_add_f32 v[34:35], v[34:35], v[40:41] op_sel:[0,1] op_sel_hi:[1,0] neg_hi:[0,1]
    v_pk_add_f32 v[40:41], v[44:45], v[92:93] op_sel:[0,1] op_sel_hi:[1,0] neg_lo:[0,1]
    v_pk_add_f32 v[44:45], v[44:45], v[92:93] op_sel:[0,1] op_sel_hi:[1,0] neg_hi:[0,1]
    v_pk_add_f32 v[92:93], v[34:35], v[44:45] neg_lo:[0,1] neg_hi:[0,1]
    v_pk_add_f32 v[34:35], v[34:35], v[44:45]
    v_pk_add_f32 v[44:45], v[42:43], v[40:41] op_sel:[0,1] op_sel_hi:[1,0] neg_hi:[0,1]
    v_pk_add_f32 v[42:43], v[42:43], v[40:41] op_sel:[0,1] op_sel_hi:[1,0] neg_lo:[0,1]
    ds_write_b64 v24, v[32:33] offset:0
    v_pk_mul_f32 v[36:37], v[34:35], v[62:63] op_sel:[0,0] op_sel_hi:[1,0]
    v_pk_fma_f32 v[34:35], v[34:35], v[62:63], v[36:37] op_sel:[1,1,0] op_sel_hi:[0,1,1] neg_lo:[0,1,0]
    ds_write_b64 v24, v[34:35] offset:640
    v_pk_mul_f32 v[40:41], v[94:95], v[64:65] op_sel:[0,0] op_sel_hi:[1,0]
    v_pk_fma_f32 v[94:95], v[94:95], v[64:65], v[40:41] op_sel:[1,1,0] op_sel_hi:[0,1,1] neg_lo:[0,1,0]
    ds_write_b64 v24, v[94:95] offset:1280
    v_pk_mul_f32 v[32:33], v[44:45], v[66:67] op_sel:[0,0] op_sel_hi:[1,0]
    v_pk_fma_f32 v[44:45], v[44:45], v[66:67], v[32:33] op_sel:[1,1,0] op_sel_hi:[0,1,1] neg_lo:[0,1,0]
    ds_write_b64 v24, v[44:45] offset:1920
    v_pk_mul_f32 v[36:37], v[38:39], v[68:69] op_sel:[0,0] op_sel_hi:[1,0]
    v_pk_fma_f32 v[38:39], v[38:39], v[68:69], v[36:37] op_sel:[1,1,0] op_sel_hi:[0,1,1] neg_lo:[0,1,0]
    ds_write_b64 v24, v[38:39] offset:2560
    v_pk_mul_f32 v[34:35], v[92:93], v[70:71] op_sel:[0,0] op_sel_hi:[1,0]
    v_pk_fma_f32 v[92:93], v[92:93], v[70:71], v[34:35] op_sel:[1,1,0] op_sel_hi:[0,1,1] neg_lo:[0,1,0]
    ds_write_b64 v24, v[92:93] offset:3200
    v_pk_mul_f32 v[40:41], v[46:47], v[72:73] op_sel:[0,0] op_sel_hi:[1,0]
    v_pk_fma_f32 v[46:47], v[46:47], v[72:73], v[40:41] op_sel:[1,1,0] op_sel_hi:[0,1,1] neg_lo:[0,1,0]
    ds_write_b64 v24, v[46:47] offset:3840
    v_pk_mul_f32 v[94:95], v[42:43], v[74:75] op_sel:[0,0] op_sel_hi:[1,0]
    v_pk_fma_f32 v[42:43], v[42:43], v[74:75], v[94:95] op_sel:[1,1,0] op_sel_hi:[0,1,1] neg_lo:[0,1,0]
    ds_write_b64 v24, v[42:43] offset:4480
    ds_read_b128 v[32:35], v25 offset:0
    ds_read_b128 v[36:39], v25 offset:16
    ds_read_b128 v[40:43], v25 offset:32
    ds_read_b128 v[44:47], v25 offset:48
    s_waitcnt lgkmcnt(0)
    v_pk_add_f32 v[92:93], v[32:33], v[40:41] neg_lo:[0,1] neg_hi:[0,1]
    v_pk_add_f32 v[32:33], v[32:33], v[40:41]
    v_pk_add_f32 v[94:95], v[34:35], v[42:43] neg_lo:[0,1] neg_hi:[0,1]
    v_pk_add_f32 v[34:35], v[34:35], v[42:43]
    v_pk_mul_f32 v[40:41], v[94:95], s[22:23] op_sel:[0,0] op_sel_hi:[1,0]
    v_pk_fma_f32 v[94:95], v[94:95], s[22:23], v[40:41] op_sel:[1,1,0] op_sel_hi:[0,1,1] neg_lo:[0,1,0]
    v_pk_add_f32 v[42:43], v[36:37], v[44:45] neg_lo:[0,1] neg_hi:[0,1]
    v_pk_add_f32 v[36:37], v[36:37], v[44:45]
    v_pk_add_f32 v[40:41], v[38:39], v[46:47] neg_lo:[0,1] neg_hi:[0,1]
    v_pk_add_f32 v[38:39], v[38:39], v[46:47]
    v_pk_mul_f32 v[44:45], v[40:41], s[22:23] op_sel:[0,0] op_sel_hi:[1,0]
    v_pk_fma_f32 v[40:41], v[40:41], s[22:23], v[44:45] op_sel:[1,1,0] op_sel_hi:[0,1,1] neg_lo:[0,1,0]
    v_pk_add_f32 v[46:47], v[32:33], v[36:37] neg_lo:[0,1] neg_hi:[0,1]
    v_pk_add_f32 v[32:33], v[32:33], v[36:37]
    v_pk_add_f32 v[36:37], v[34:35], v[38:39] neg_lo:[0,1] neg_hi:[0,1]
    v_pk_add_f32 v[34:35], v[34:35], v[38:39]
    v_pk_add_f32 v[38:39], v[32:33], v[34:35] neg_lo:[0,1] neg_hi:[0,1]
    v_pk_add_f32 v[32:33], v[32:33], v[34:35]
    v_pk_add_f32 v[34:35], v[46:47], v[36:37] op_sel:[0,1] op_sel_hi:[1,0] neg_hi:[0,1]
    v_pk_add_f32 v[46:47], v[46:47], v[36:37] op_sel:[0,1] op_sel_hi:[1,0] neg_lo:[0,1]
    v_pk_add_f32 v[44:45], v[92:93], v[42:43] op_sel:[0,1] op_sel_hi:[1,0] neg_lo:[0,1]
    v_pk_add_f32 v[92:93], v[92:93], v[42:43] op_sel:[0,1] op_sel_hi:[1,0] neg_hi:[0,1]
    v_pk_add_f32 v[42:43], v[94:95], v[40:41] op_sel:[0,1] op_sel_hi:[1,0] neg_lo:[0,1]
    v_pk_add_f32 v[94:95], v[94:95], v[40:41] op_sel:[0,1] op_sel_hi:[1,0] neg_hi:[0,1]
    v_pk_add_f32 v[40:41], v[92:93], v[94:95] neg_lo:[0,1] neg_hi:[0,1]
    v_pk_add_f32 v[92:93], v[92:93], v[94:95]
    v_pk_add_f32 v[94:95], v[44:45], v[42:43] op_sel:[0,1] op_sel_hi:[1,0] neg_hi:[0,1]
    v_pk_add_f32 v[44:45], v[44:45], v[42:43] op_sel:[0,1] op_sel_hi:[1,0] neg_lo:[0,1]
    v_cvt_pk_bf16_f32 v84, v32, v33
    v_cvt_pk_bf16_f32 v85, v92, v93
    v_cvt_pk_bf16_f32 v86, v34, v35
    v_cvt_pk_bf16_f32 v87, v94, v95
    v_cvt_pk_bf16_f32 v88, v38, v39
    v_cvt_pk_bf16_f32 v89, v40, v41
    v_cvt_pk_bf16_f32 v90, v46, v47
    v_cvt_pk_bf16_f32 v91, v44, v45
    s_barrier
    ds_write_b32 v30, v76 offset:0
    ds_write_b32 v30, v77 offset:2304
    ds_write_b32 v30, v78 offset:4608
    ds_write_b32 v30, v79 offset:6912
    ds_write_b32 v30, v80 offset:9216
    ds_write_b32 v30, v81 offset:11520
    ds_write_b32 v30, v82 offset:13824
    ds_write_b32 v30, v83 offset:16128
    ds_write_b32 v30, v84 offset:16
    ds_write_b32 v30, v85 offset:2320
    ds_write_b32 v30, v86 offset:4624
    ds_write_b32 v30, v87 offset:6928
    ds_write_b32 v30, v88 offset:9232
    ds_write_b32 v30, v89 offset:11536
    ds_write_b32 v30, v90 offset:13840
    ds_write_b32 v30, v91 offset:16144
    s_waitcnt lgkmcnt(0)
    s_barrier
    ds_read_b128 v[32:35], v4 offset:0
    ds_read_b128 v[36:39], v4 offset:4608
    ds_read_b128 v[40:43], v4 offset:9216
    ds_read_b128 v[44:47], v4 offset:13824
    s_lshl_b32 s31, s2, 7
    s_add_u32 s31, s31, 0
    s_waitcnt lgkmcnt(3)
    buffer_store_dwordx4 v[32:35], v3, s[32:35], s31 offen sc1
    s_add_u32 s31, s31, 1048576
    s_waitcnt lgkmcnt(2)
    buffer_store_dwordx4 v[36:39], v3, s[32:35], s31 offen sc1
    s_add_u32 s31, s31, 1048576
    s_waitcnt lgkmcnt(1)
    buffer_store_dwordx4 v[40:43], v3, s[32:35], s31 offen sc1
    s_add_u32 s31, s31, 1048576
    s_waitcnt lgkmcnt(0)
    buffer_store_dwordx4 v[44:47], v3, s[32:35], s31 offen sc1
    s_endpgm
.p2align 6
L_k1_kernel_r1:
    s_mov_b32 s57, 67633152
    s_load_dwordx8 s[64:71], s[0:1], 32
    s_load_dwordx2 s[72:73], s[0:1], 64
    s_load_dwordx2 s[80:81], s[0:1], 96
    v_lshrrev_b32 v1, 6, v0
    s_nop 0
    v_readfirstlane_b32 s30, v1
    v_and_b32 v2, 63, v0
    s_lshr_b32 s28, s30, 1
    s_and_b32 s29, s30, 1
    s_lshl_b32 s31, s2, 1
    s_add_u32 s31, s31, s28
    s_waitcnt lgkmcnt(0)
    s_mov_b32 s8, s64
    s_mov_b32 s9, s65
    s_mov_b32 s10, 262144
    s_mov_b32 s11, 0x00020000
    s_mov_b32 s12, s66
    s_mov_b32 s13, s67
    s_mov_b32 s14, 262144
    s_mov_b32 s15, 0x00020000
    s_mov_b32 s20, s68
    s_mov_b32 s21, s69
    s_mov_b32 s22, 262144
    s_mov_b32 s23, 0x00020000
    s_mov_b32 s24, s70
    s_mov_b32 s25, s71
    s_mov_b32 s26, 262144
    s_mov_b32 s27, 0x00020000
    s_mov_b32 s32, s72
    s_mov_b32 s33, s73
    s_mov_b32 s34, 2048
    s_mov_b32 s35, 0x00020000
    s_mov_b32 s44, s80
    s_mov_b32 s45, s81
    s_mov_b32 s46, 268435456
    s_mov_b32 s47, 0x00020000
    v_lshlrev_b32 v3, 1, v2
    s_lshl_b32 s48, s31, 8
    s_lshl_b32 s49, s29, 7
    s_add_u32 s48, s48, s49
    s_lshl_b32 s49, s31, 1
    v_mov_b32 v4, 0
    buffer_load_short_d16_hi v24, v3, s[8:11], s48 offen
    buffer_load_short_d16_hi v25, v3, s[12:15], s48 offen
    buffer_load_short_d16_hi v26, v3, s[20:23], s48 offen
    buffer_load_short_d16_hi v27, v3, s[24:27], s48 offen
    buffer_load_short_d16_hi v14, v4, s[32:35], s49 offen
    s_lshl_b32 s51, s30, 10
    v_lshlrev_b32 v7, 4, v2
    v_add_u32 v7, s51, v7
    v_and_b32 v16, 15, v2
    v_lshrrev_b32 v17, 4, v2
    v_cvt_f32_u32 v18, v16
    v_mul_f32 v19, 0x41800000, v18
    v_cmp_eq_u32 s[54:55], 0, v16
    v_mov_b32 v20, 0x43800000
    s_nop 0
    v_cndmask_b32 v19, v19, v20, s[54:55]
    v_lshlrev_b32 v21, 6, v17
    v_add_u32 v21, s51, v21
    v_mov_b32 v32, 0
    v_mov_b32 v33, 0
    v_mov_b32 v34, 0
    v_mov_b32 v35, 0
    v_mov_b32 v36, 0
    v_mov_b32 v37, 0
    v_mov_b32 v38, 0
    v_mov_b32 v39, 0
    v_mov_b32 v40, 0
    v_mov_b32 v41, 0
    v_mov_b32 v42, 0
    v_mov_b32 v43, 0
    v_mov_b32 v44, 0
    v_mov_b32 v45, 0
    v_mov_b32 v46, 0
    v_mov_b32 v47, 0
    s_waitcnt vmcnt(0)
    v_mul_f32 v14, 0x3fb8aa3b, v14
    v_exp_f32 v14, v14
    v_mul_f32 v24, 0x3fb8aa3b, v24
    v_exp_f32 v24, v24
    v_cvt_pk_bf16_f32 v14, v14, v14
    v_lshlrev_b32 v14, 16, v14
    v_cvt_pk_bf16_f32 v24, v24, v24
    v_lshlrev_b32 v24, 16, v24
    v_mul_f32 v25, v25, v14
    v_mul_f32 v24, v24, v14
    v_mul_f32 v24, 0xbfb8aa3b, v24
    v_mul_f32 v25, 0x3e22f983, v25
    v_add_f32 v14, v14, v14
    v_mul_f32 v26, v26, v14
    v_mul_f32 v27, v27, v14
    v_max_f32_e64 v28, |v26|, |v27|
    ds_swizzle_b32 v29, v28 offset:1055
    s_waitcnt lgkmcnt(0)
    v_max_f32 v28, v28, v29
    ds_swizzle_b32 v29, v28 offset:2079
    s_waitcnt lgkmcnt(0)
    v_max_f32 v28, v28, v29
    ds_swizzle_b32 v29, v28 offset:4127
    s_waitcnt lgkmcnt(0)
    v_max_f32 v28, v28, v29
    ds_swizzle_b32 v29, v28 offset:8223
    s_waitcnt lgkmcnt(0)
    v_max_f32 v28, v28, v29
    ds_swizzle_b32 v29, v28 offset:16415
    s_waitcnt lgkmcnt(0)
    v_max_f32 v28, v28, v29
    s_nop 0
    v_readlane_b32 s40, v28, 0
    v_readlane_b32 s41, v28, 32
    s_nop 1
    v_mov_b32 v28, s40
    v_max_f32 v28, s41, v28
    v_frexp_exp_i32_f32 v29, v28
    v_sub_u32 v30, 0, v29
    v_ldexp_f32 v26, v26, v30
    v_ldexp_f32 v27, v27, v30
    v_cvt_pk_f16_f32 v26, v26, v27
    ds_write_b128 v7, v[24:27]
    s_mov_b32 s56, 0
L_k1_kernel_r1_kg:
    ds_read_b128 v[80:83], v21 offset:0
    ds_read_b128 v[84:87], v21 offset:16
    ds_read_b128 v[88:91], v21 offset:32
    ds_read_b128 v[92:95], v21 offset:48
    v_add_u32 v21, 256, v21
    s_waitcnt lgkmcnt(3)
    v_mul_f32 v22, v80, v18
    v_mul_f32 v23, v81, v18
    v_exp_f32 v22, v22
    v_fract_f32 v23, v23
    v_cos_f32 v10, v23
    v_sin_f32_e64 v11, -v23
    v_mul_f32 v10, v10, v22
    v_mul_f32 v11, v11, v22
    v_mul_f32 v22, v80, v19
    v_mul_f32 v23, v81, v19
    v_exp_f32 v22, v22
    v_fract_f32 v23, v23
    v_cos_f32 v12, v23
    v_sin_f32_e64 v13, v23
    v_mul_f32 v12, v12, v22
    v_mul_f32 v13, v13, v22
    v_cvt_pk_f16_f32 v64, v10, v11
    v_cvt_pk_f16_f32 v12, v12, v13
    v_pk_mul_f16 v22, v12, v82 op_sel:[0,0] op_sel_hi:[1,0]
    v_pk_fma_f16 v23, v12, v82, v22 op_sel:[1,1,0] op_sel_hi:[0,1,1] neg_lo:[0,1,0]
    v_cndmask_b32 v48, v23, v82, s[54:55]
    v_pk_mul_f16 v22, v23, v12 op_sel:[0,0] op_sel_hi:[1,0]
    v_pk_fma_f16 v52, v23, v12, v22 op_sel:[1,1,0] op_sel_hi:[0,1,1] neg_lo:[0,1,0]
    v_pk_mul_f16 v22, v12, v12 op_sel:[0,0] op_sel_hi:[1,0]
    v_pk_fma_f16 v12, v12, v12, v22 op_sel:[1,1,0] op_sel_hi:[0,1,1] neg_lo:[0,1,0]
    v_pk_mul_f16 v22, v64, v64 op_sel:[0,0] op_sel_hi:[1,0]
    v_pk_fma_f16 v68, v64, v64, v22 op_sel:[1,1,0] op_sel_hi:[0,1,1] neg_lo:[0,1,0]
    v_pk_mul_f16 v22, v52, v12 op_sel:[0,0] op_sel_hi:[1,0]
    v_pk_fma_f16 v56, v52, v12, v22 op_sel:[1,1,0] op_sel_hi:[0,1,1] neg_lo:[0,1,0]
    v_pk_mul_f16 v22, v12, v12 op_sel:[0,0] op_sel_hi:[1,0]
    v_pk_fma_f16 v12, v12, v12, v22 op_sel:[1,1,0] op_sel_hi:[0,1,1] neg_lo:[0,1,0]
    v_pk_mul_f16 v22, v68, v68 op_sel:[0,0] op_sel_hi:[1,0]
    v_pk_fma_f16 v72, v68, v68, v22 op_sel:[1,1,0] op_sel_hi:[0,1,1] neg_lo:[0,1,0]
    v_pk_mul_f16 v22, v56, v12 op_sel:[0,0] op_sel_hi:[1,0]
    v_pk_fma_f16 v60, v56, v12, v22 op_sel:[1,1,0] op_sel_hi:[0,1,1] neg_lo:[0,1,0]
    v_pk_mul_f16 v22, v72, v72 op_sel:[0,0] op_sel_hi:[1,0]
    v_pk_fma_f16 v76, v72, v72, v22 op_sel:[1,1,0] op_sel_hi:[0,1,1] neg_lo:[0,1,0]
    s_waitcnt lgkmcnt(2)
    v_mul_f32 v22, v84, v18
    v_mul_f32 v23, v85, v18
    v_exp_f32 v22, v22
    v_fract_f32 v23, v23
    v_cos_f32 v10, v23
    v_sin_f32_e64 v11, -v23
    v_mul_f32 v10, v10, v22
    v_mul_f32 v11, v11, v22
    v_mul_f32 v22, v84, v19
    v_mul_f32 v23, v85, v19
    v_exp_f32 v22, v22
    v_fract_f32 v23, v23
    v_cos_f32 v12, v23
    v_sin_f32_e64 v13, v23
    v_mul_f32 v12, v12, v22
    v_mul_f32 v13, v13, v22
    v_cvt_pk_f16_f32 v65, v10, v11
    v_cvt_pk_f16_f32 v12, v12, v13
    v_pk_mul_f16 v22, v12, v86 op_sel:[0,0] op_sel_hi:[1,0]
    v_pk_fma_f16 v23, v12, v86, v22 op_sel:[1,1,0] op_sel_hi:[0,1,1] neg_lo:[0,1,0]
    v_cndmask_b32 v49, v23, v86, s[54:55]
    v_pk_mul_f16 v22, v23, v12 op_sel:[0,0] op_sel_hi:[1,0]
    v_pk_fma_f16 v53, v23, v12, v22 op_sel:[1,1,0] op_sel_hi:[0,1,1] neg_lo:[0,1,0]
    v_pk_mul_f16 v22, v12, v12 op_sel:[0,0] op_sel_hi:[1,0]
    v_pk_fma_f16 v12, v12, v12, v22 op_sel:[1,1,0] op_sel_hi:[0,1,1] neg_lo:[0,1,0]
    v_pk_mul_f16 v22, v65, v65 op_sel:[0,0] op_sel_hi:[1,0]
    v_pk_fma_f16 v69, v65, v65, v22 op_sel:[1,1,0] op_sel_hi:[0,1,1] neg_lo:[0,1,0]
    v_pk_mul_f16 v22, v53, v12 op_sel:[0,0] op_sel_hi:[1,0]
    v_pk_fma_f16 v57, v53, v12, v22 op_sel:[1,1,0] op_sel_hi:[0,1,1] neg_lo:[0,1,0]
    v_pk_mul_f16 v22, v12, v12 op_sel:[0,0] op_sel_hi:[1,0]
    v_pk_fma_f16 v12, v12, v12, v22 op_sel:[1,1,0] op_sel_hi:[0,1,1] neg_lo:[0,1,0]
    v_pk_mul_f16 v22, v69, v69 op_sel:[0,0] op_sel_hi:[1,0]
    v_pk_fma_f16 v73, v69, v69, v22 op_sel:[1,1,0] op_sel_hi:[0,1,1] neg_lo:[0,1,0]
    v_pk_mul_f16 v22, v57, v12 op_sel:[0,0] op_sel_hi:[1,0]
    v_pk_fma_f16 v61, v57, v12, v22 op_sel:[1,1,0] op_sel_hi:[0,1,1] neg_lo:[0,1,0]
    v_pk_mul_f16 v22, v73, v73 op_sel:[0,0] op_sel_hi:[1,0]
    v_pk_fma_f16 v77, v73, v73, v22 op_sel:[1,1,0] op_sel_hi:[0,1,1] neg_lo:[0,1,0]
    s_waitcnt lgkmcnt(1)
    v_mul_f32 v22, v88, v18
    v_mul_f32 v23, v89, v18
    v_exp_f32 v22, v22
    v_fract_f32 v23, v23
    v_cos_f32 v10, v23
    v_sin_f32_e64 v11, -v23
    v_mul_f32 v10, v10, v22
    v_mul_f32 v11, v11, v22
    v_mul_f32 v22, v88, v19
    v_mul_f32 v23, v89, v19
    v_exp_f32 v22, v22
    v_fract_f32 v23, v23
    v_cos_f32 v12, v23
    v_sin_f32_e64 v13, v23
    v_mul_f32 v12, v12, v22
    v_mul_f32 v13, v13, v22
    v_cvt_pk_f16_f32 v66, v10, v11
    v_cvt_pk_f16_f32 v12, v12, v13
    v_pk_mul_f16 v22, v12, v90 op_sel:[0,0] op_sel_hi:[1,0]
    v_pk_fma_f16 v23, v12, v90, v22 op_sel:[1,1,0] op_sel_hi:[0,1,1] neg_lo:[0,1,0]
    v_cndmask_b32 v50, v23, v90, s[54:55]
    v_pk_mul_f16 v22, v23, v12 op_sel:[0,0] op_sel_hi:[1,0]
    v_pk_fma_f16 v54, v23, v12, v22 op_sel:[1,1,0] op_sel_hi:[0,1,1] neg_lo:[0,1,0]
    v_pk_mul_f16 v22, v12, v12 op_sel:[0,0] op_sel_hi:[1,0]
    v_pk_fma_f16 v12, v12, v12, v22 op_sel:[1,1,0] op_sel_hi:[0,1,1] neg_lo:[0,1,0]
    v_pk_mul_f16 v22, v66, v66 op_sel:[0,0] op_sel_hi:[1,0]
    v_pk_fma_f16 v70, v66, v66, v22 op_sel:[1,1,0] op_sel_hi:[0,1,1] neg_lo:[0,1,0]
    v_pk_mul_f16 v22, v54, v12 op_sel:[0,0] op_sel_hi:[1,0]
    v_pk_fma_f16 v58, v54, v12, v22 op_sel:[1,1,0] op_sel_hi:[0,1,1] neg_lo:[0,1,0]
    v_pk_mul_f16 v22, v12, v12 op_sel:[0,0] op_sel_hi:[1,0]
    v_pk_fma_f16 v12, v12, v12, v22 op_sel:[1,1,0] op_sel_hi:[0,1,1] neg_lo:[0,1,0]
    v_pk_mul_f16 v22, v70, v70 op_sel:[0,0] op_sel_hi:[1,0]
    v_pk_fma_f16 v74, v70, v70, v22 op_sel:[1,1,0] op_sel_hi:[0,1,1] neg_lo:[0,1,0]
    v_pk_mul_f16 v22, v58, v12 op_sel:[0,0] op_sel_hi:[1,0]
    v_pk_fma_f16 v62, v58, v12, v22 op_sel:[1,1,0] op_sel_hi:[0,1,1] neg_lo:[0,1,0]
    v_pk_mul_f16 v22, v74, v74 op_sel:[0,0] op_sel_hi:[1,0]
    v_pk_fma_f16 v78, v74, v74, v22 op_sel:[1,1,0] op_sel_hi:[0,1,1] neg_lo:[0,1,0]
    s_waitcnt lgkmcnt(0)
    v_mul_f32 v22, v92, v18
    v_mul_f32 v23, v93, v18
    v_exp_f32 v22, v22
    v_fract_f32 v23, v23
    v_cos_f32 v10, v23
    v_sin_f32_e64 v11, -v23
    v_mul_f32 v10, v10, v22
    v_mul_f32 v11, v11, v22
    v_mul_f32 v22, v92, v19
    v_mul_f32 v23, v93, v19
    v_exp_f32 v22, v22
    v_fract_f32 v23, v23
    v_cos_f32 v12, v23
    v_sin_f32_e64 v13, v23
    v_mul_f32 v12, v12, v22
    v_mul_f32 v13, v13, v22
    v_cvt_pk_f16_f32 v67, v10, v11
    v_cvt_pk_f16_f32 v12, v12, v13
    v_pk_mul_f16 v22, v12, v94 op_sel:[0,0] op_sel_hi:[1,0]
    v_pk_fma_f16 v23, v12, v94, v22 op_sel:[1,1,0] op_sel_hi:[0,1,1] neg_lo:[0,1,0]
    v_cndmask_b32 v51, v23, v94, s[54:55]
    v_pk_mul_f16 v22, v23, v12 op_sel:[0,0] op_sel_hi:[1,0]
    v_pk_fma_f16 v55, v23, v12, v22 op_sel:[1,1,0] op_sel_hi:[0,1,1] neg_lo:[0,1,0]
    v_pk_mul_f16 v22, v12, v12 op_sel:[0,0] op_sel_hi:[1,0]
    v_pk_fma_f16 v12, v12, v12, v22 op_sel:[1,1,0] op_sel_hi:[0,1,1] neg_lo:[0,1,0]
    v_pk_mul_f16 v22, v67, v67 op_sel:[0,0] op_sel_hi:[1,0]
    v_pk_fma_f16 v71, v67, v67, v22 op_sel:[1,1,0] op_sel_hi:[0,1,1] neg_lo:[0,1,0]
    v_pk_mul_f16 v22, v55, v12 op_sel:[0,0] op_sel_hi:[1,0]
    v_pk_fma_f16 v59, v55, v12, v22 op_sel:[1,1,0] op_sel_hi:[0,1,1] neg_lo:[0,1,0]
    v_pk_mul_f16 v22, v12, v12 op_sel:[0,0] op_sel_hi:[1,0]
    v_pk_fma_f16 v12, v12, v12, v22 op_sel:[1,1,0] op_sel_hi:[0,1,1] neg_lo:[0,1,0]
    v_pk_mul_f16 v22, v71, v71 op_sel:[0,0] op_sel_hi:[1,0]
    v_pk_fma_f16 v75, v71, v71, v22 op_sel:[1,1,0] op_sel_hi:[0,1,1] neg_lo:[0,1,0]
    v_pk_mul_f16 v22, v59, v12 op_sel:[0,0] op_sel_hi:[1,0]
    v_pk_fma_f16 v63, v59, v12, v22 op_sel:[1,1,0] op_sel_hi:[0,1,1] neg_lo:[0,1,0]
    v_pk_mul_f16 v22, v75, v75 op_sel:[0,0] op_sel_hi:[1,0]
    v_pk_fma_f16 v79, v75, v75, v22 op_sel:[1,1,0] op_sel_hi:[0,1,1] neg_lo:[0,1,0]
    s_nop 1
    v_mfma_f32_16x16x32_f16 v[32:35], v[48:51], v[64:67], v[32:35]
    v_mfma_f32_16x16x32_f16 v[36:39], v[52:55], v[68:71], v[36:39]
    v_mfma_f32_16x16x32_f16 v[40:43], v[56:59], v[72:75], v[40:43]
    v_mfma_f32_16x16x32_f16 v[44:47], v[60:63], v[76:79], v[44:47]
    s_add_u32 s56, s56, 1
    s_cmp_lt_u32 s56, 4
    s_cbranch_scc1 L_k1_kernel_r1_kg
    s_lshl_b32 s52, s30, 12
    s_add_u32 s52, s52, 4096
    s_xor_b32 s53, s30, 1
    s_lshl_b32 s53, s53, 12
    s_add_u32 s53, s53, 4096
    v_lshlrev_b32 v5, 4, v2
    v_add_u32 v6, s52, v5
    v_add_u32 v8, s53, v5
    s_mul_i32 s58, s30, 1344
    s_add_u32 s58, s58, 20480
    v_lshlrev_b32 v22, 7, v17
    v_lshl_add_u32 v22, v16, 1, v22
    v_add_u32 v22, s58, v22
    s_nop 3
    v_ldexp_f32 v32, v32, v29
    v_ldexp_f32 v33, v33, v29
    v_ldexp_f32 v34, v34, v29
    v_ldexp_f32 v35, v35, v29
    v_ldexp_f32 v36, v36, v29
    v_ldexp_f32 v37, v37, v29
    v_ldexp_f32 v38, v38, v29
    v_ldexp_f32 v39, v39, v29
    v_ldexp_f32 v40, v40, v29
    v_ldexp_f32 v41, v41, v29
    v_ldexp_f32 v42, v42, v29
    v_ldexp_f32 v43, v43, v29
    v_ldexp_f32 v44, v44, v29
    v_ldexp_f32 v45, v45, v29
    v_ldexp_f32 v46, v46, v29
    v_ldexp_f32 v47, v47, v29
    ds_write_b128 v6, v[32:35] offset:0
    ds_write_b128 v6, v[36:39] offset:1024
    ds_write_b128 v6, v[40:43] offset:2048
    ds_write_b128 v6, v[44:47] offset:3072
    s_waitcnt lgkmcnt(0)
    s_barrier
    ds_read_b128 v[48:51], v8 offset:0
    ds_read_b128 v[52:55], v8 offset:1024
    ds_read_b128 v[56:59], v8 offset:2048
    ds_read_b128 v[60:63], v8 offset:3072
    s_waitcnt lgkmcnt(3)
    v_add_f32 v32, v32, v48
    v_cvt_pk_bf16_f32 v32, v32, v32
    v_add_f32 v33, v33, v49
    v_cvt_pk_bf16_f32 v33, v33, v33
    v_add_f32 v34, v34, v50
    v_cvt_pk_bf16_f32 v34, v34, v34
    v_add_f32 v35, v35, v51
    v_cvt_pk_bf16_f32 v35, v35, v35
    s_waitcnt lgkmcnt(2)
    v_add_f32 v36, v36, v52
    v_cvt_pk_bf16_f32 v36, v36, v36
    v_add_f32 v37, v37, v53
    v_cvt_pk_bf16_f32 v37, v37, v37
    v_add_f32 v38, v38, v54
    v_cvt_pk_bf16_f32 v38, v38, v38
    v_add_f32 v39, v39, v55
    v_cvt_pk_bf16_f32 v39, v39, v39
    s_waitcnt lgkmcnt(1)
    v_add_f32 v40, v40, v56
    v_cvt_pk_bf16_f32 v40, v40, v40
    v_add_f32 v41, v41, v57
    v_cvt_pk_bf16_f32 v41, v41, v41
    v_add_f32 v42, v42, v58
    v_cvt_pk_bf16_f32 v42, v42, v42
    v_add_f32 v43, v43, v59
    v_cvt_pk_bf16_f32 v43, v43, v43
    s_waitcnt lgkmcnt(0)
    v_add_f32 v44, v44, v60
    v_cvt_pk_bf16_f32 v44, v44, v44
    v_add_f32 v45, v45, v61
    v_cvt_pk_bf16_f32 v45, v45, v45
    v_add_f32 v46, v46, v62
    v_cvt_pk_bf16_f32 v46, v46, v46
    v_add_f32 v47, v47, v63
    v_cvt_pk_bf16_f32 v47, v47, v47
    ds_write_b16 v22, v32 offset:0
    ds_write_b16 v22, v33 offset:32
    ds_write_b16 v22, v34 offset:64
    ds_write_b16 v22, v35 offset:96
    s_mov_b32 exec_lo, 0
    ds_write_b16 v22, v36 offset:256
    ds_write_b16 v22, v37 offset:288
    ds_write_b16 v22, v38 offset:320
    ds_write_b16 v22, v39 offset:352
    ds_write_b16 v22, v40 offset:512
    ds_write_b16 v22, v41 offset:544
    ds_write_b16 v22, v42 offset:576
    ds_write_b16 v22, v43 offset:608
    ds_write_b16 v22, v44 offset:768
    ds_write_b16 v22, v45 offset:800
    ds_write_b16 v22, v46 offset:832
    ds_write_b16 v22, v47 offset:864
    s_mov_b64 exec, 1
    ds_write_b16 v22, v44 offset:1280
    s_mov_b64 exec, -1
    v_lshlrev_b32 v24, 4, v2
    v_add_u32 v25, s58, v24
    s_mul_i32 s49, s31, 1408
    s_add_u32 s49, s49, 50331648
    s_cmp_eq_u32 s29, 1
    s_cbranch_scc1 L_k1_kernel_r1_p1
    ds_read_b128 v[48:51], v25
    s_waitcnt lgkmcnt(0)
    buffer_store_dwordx4 v[48:51], v24, s[44:47], s49 offen sc1
    s_branch L_k1_kernel_r1_done
L_k1_kernel_r1_p1:
    s_mov_b64 exec, 0x3ffff
    ds_read_b128 v[48:51], v25 offset:1024
    s_waitcnt lgkmcnt(0)
    buffer_store_dwordx4 v[48:51], v24, s[44:47], s49 offen offset:1024 sc1
    s_mov_b64 exec, -1
L_k1_kernel_r1_done:
    s_endpgm
.p2align 6
L_k1_kernel_r2:
    s_mov_b32 s57, 68157440
    s_load_dwordx2 s[4:5], s[0:1], 8
    s_load_dwordx2 s[6:7], s[0:1], 16
    s_load_dwordx2 s[28:29], s[0:1], 96
    v_lshrrev_b32 v5, 6, v0
    s_nop 0
    v_readfirstlane_b32 s30, v5
    v_and_b32 v6, 63, v0
    s_and_b32 s16, s2, 31
    s_lshr_b32 s17, s2, 5
    s_lshl_b32 s18, s16, 6
    s_lshl_b32 s19, s30, 4
    s_add_u32 s19, s19, s18
    s_mul_i32 s19, s19, 1026
    s_lshl_b32 s31, s17, 7
    s_add_u32 s19, s19, s31
    v_lshlrev_b32 v7, 1, v6
    s_lshl_b32 s36, s17, 6
    v_add_u32 v8, s36, v6
    s_waitcnt lgkmcnt(0)
    s_mov_b32 s8, s4
    s_mov_b32 s9, s5
    s_mov_b32 s10, 2101248
    s_mov_b32 s11, 0x00020000
    s_mov_b32 s12, s6
    s_mov_b32 s13, s7
    s_mov_b32 s14, 2101248
    s_mov_b32 s15, 0x00020000
    s_mov_b32 s32, s28
    s_mov_b32 s33, s29
    s_mov_b32 s34, 268435456
    s_mov_b32 s35, 0x00020000
    v_cmp_gt_u32 vcc, 513, v8
    s_and_saveexec_b64 s[38:39], vcc
    buffer_load_ushort v16, v7, s[8:11], s19 offen
    buffer_load_short_d16_hi v32, v7, s[12:15], s19 offen
    s_add_u32 s19, s19, 1026
    buffer_load_ushort v17, v7, s[8:11], s19 offen
    buffer_load_short_d16_hi v33, v7, s[12:15], s19 offen
    s_add_u32 s19, s19, 1026
    buffer_load_ushort v18, v7, s[8:11], s19 offen
    buffer_load_short_d16_hi v34, v7, s[12:15], s19 offen
    s_add_u32 s19, s19, 1026
    buffer_load_ushort v19, v7, s[8:11], s19 offen
    buffer_load_short_d16_hi v35, v7, s[12:15], s19 offen
    s_add_u32 s19, s19, 1026
    buffer_load_ushort v20, v7, s[8:11], s19 offen
    buffer_load_short_d16_hi v36, v7, s[12:15], s19 offen
    s_add_u32 s19, s19, 1026
    buffer_load_ushort v21, v7, s[8:11], s19 offen
    buffer_load_short_d16_hi v37, v7, s[12:15], s19 offen
    s_add_u32 s19, s19, 1026
    buffer_load_ushort v22, v7, s[8:11], s19 offen
    buffer_load_short_d16_hi v38, v7, s[12:15], s19 offen
    s_add_u32 s19, s19, 1026
    buffer_load_ushort v23, v7, s[8:11], s19 offen
    buffer_load_short_d16_hi v39, v7, s[12:15], s19 offen
    s_add_u32 s19, s19, 1026
    buffer_load_ushort v24, v7, s[8:11], s19 offen
    buffer_load_short_d16_hi v40, v7, s[12:15], s19 offen
    s_add_u32 s19, s19, 1026
    buffer_load_ushort v25, v7, s[8:11], s19 offen
    buffer_load_short_d16_hi v41, v7, s[12:15], s19 offen
    s_add_u32 s19, s19, 1026
    buffer_load_ushort v26, v7, s[8:11], s19 offen
    buffer_load_short_d16_hi v42, v7, s[12:15], s19 offen
    s_add_u32 s19, s19, 1026
    buffer_load_ushort v27, v7, s[8:11], s19 offen
    buffer_load_short_d16_hi v43, v7, s[12:15], s19 offen
    s_add_u32 s19, s19, 1026
    buffer_load_ushort v28, v7, s[8:11], s19 offen
    buffer_load_short_d16_hi v44, v7, s[12:15], s19 offen
    s_add_u32 s19, s19, 1026
    buffer_load_ushort v29, v7, s[8:11], s19 offen
    buffer_load_short_d16_hi v45, v7, s[12:15], s19 offen
    s_add_u32 s19, s19, 1026
    buffer_load_ushort v30, v7, s[8:11], s19 offen
    buffer_load_short_d16_hi v46, v7, s[12:15], s19 offen
    s_add_u32 s19, s19, 1026
    buffer_load_ushort v31, v7, s[8:11], s19 offen
    buffer_load_short_d16_hi v47, v7, s[12:15], s19 offen
    s_mov_b64 exec, s[38:39]
    s_mul_i32 s40, s30, 16*260
    v_lshlrev_b32 v9, 2, v6
    v_add_u32 v9, s40, v9
    s_waitcnt vmcnt(30)
    v_or_b32 v16, v16, v32
    ds_write_b32 v9, v16 offset:0
    s_waitcnt vmcnt(28)
    v_or_b32 v17, v17, v33
    ds_write_b32 v9, v17 offset:260
    s_waitcnt vmcnt(26)
    v_or_b32 v18, v18, v34
    ds_write_b32 v9, v18 offset:520
    s_waitcnt vmcnt(24)
    v_or_b32 v19, v19, v35
    ds_write_b32 v9, v19 offset:780
    s_waitcnt vmcnt(22)
    v_or_b32 v20, v20, v36
    ds_write_b32 v9, v20 offset:1040
    s_waitcnt vmcnt(20)
    v_or_b32 v21, v21, v37
    ds_write_b32 v9, v21 offset:1300
    s_waitcnt vmcnt(18)
    v_or_b32 v22, v22, v38
    ds_write_b32 v9, v22 offset:1560
    s_waitcnt vmcnt(16)
    v_or_b32 v23, v23, v39
    ds_write_b32 v9, v23 offset:1820
    s_waitcnt vmcnt(14)
    v_or_b32 v24, v24, v40
    ds_write_b32 v9, v24 offset:2080
    s_waitcnt vmcnt(12)
    v_or_b32 v25, v25, v41
    ds_write_b32 v9, v25 offset:2340
    s_waitcnt vmcnt(10)
    v_or_b32 v26, v26, v42
    ds_write_b32 v9, v26 offset:2600
    s_waitcnt vmcnt(8)
    v_or_b32 v27, v27, v43
    ds_write_b32 v9, v27 offset:2860
    s_waitcnt vmcnt(6)
    v_or_b32 v28, v28, v44
    ds_write_b32 v9, v28 offset:3120
    s_waitcnt vmcnt(4)
    v_or_b32 v29, v29, v45
    ds_write_b32 v9, v29 offset:3380
    s_waitcnt vmcnt(2)
    v_or_b32 v30, v30, v46
    ds_write_b32 v9, v30 offset:3640
    s_waitcnt vmcnt(0)
    v_or_b32 v31, v31, v47
    ds_write_b32 v9, v31 offset:3900
    s_waitcnt lgkmcnt(0)
    s_barrier
    v_mul_u32_u24 v10, 260, v6
    s_lshl_b32 s41, s30, 6
    v_add_u32 v10, s41, v10
    ds_read_b32 v16, v10 offset:0
    ds_read_b32 v17, v10 offset:4
    ds_read_b32 v18, v10 offset:8
    ds_read_b32 v19, v10 offset:12
    ds_read_b32 v20, v10 offset:16
    ds_read_b32 v21, v10 offset:20
    ds_read_b32 v22, v10 offset:24
    ds_read_b32 v23, v10 offset:28
    ds_read_b32 v24, v10 offset:32
    ds_read_b32 v25, v10 offset:36
    ds_read_b32 v26, v10 offset:40
    ds_read_b32 v27, v10 offset:44
    ds_read_b32 v28, v10 offset:48
    ds_read_b32 v29, v10 offset:52
    ds_read_b32 v30, v10 offset:56
    ds_read_b32 v31, v10 offset:60
    s_lshl_b32 s42, s30, 4
    s_add_u32 s42, s42, s36
    s_lshl_b32 s43, s18, 2
    s_add_u32 s43, s43, 33554432
    v_lshlrev_b32 v11, 2, v6
    s_waitcnt lgkmcnt(15)
    s_cmp_gt_u32 s42, 512
    s_cbranch_scc1 L_k1_kernel_r2_done
    s_lshl_b32 s44, s42, 13
    s_add_u32 s44, s44, s43
    buffer_store_dword v16, v11, s[32:35], s44 offen sc1
    s_add_u32 s42, s42, 1
    s_waitcnt lgkmcnt(14)
    s_cmp_gt_u32 s42, 512
    s_cbranch_scc1 L_k1_kernel_r2_done
    s_lshl_b32 s44, s42, 13
    s_add_u32 s44, s44, s43
    buffer_store_dword v17, v11, s[32:35], s44 offen sc1
    s_add_u32 s42, s42, 1
    s_waitcnt lgkmcnt(13)
    s_cmp_gt_u32 s42, 512
    s_cbranch_scc1 L_k1_kernel_r2_done
    s_lshl_b32 s44, s42, 13
    s_add_u32 s44, s44, s43
    buffer_store_dword v18, v11, s[32:35], s44 offen sc1
    s_add_u32 s42, s42, 1
    s_waitcnt lgkmcnt(12)
    s_cmp_gt_u32 s42, 512
    s_cbranch_scc1 L_k1_kernel_r2_done
    s_lshl_b32 s44, s42, 13
    s_add_u32 s44, s44, s43
    buffer_store_dword v19, v11, s[32:35], s44 offen sc1
    s_add_u32 s42, s42, 1
    s_waitcnt lgkmcnt(11)
    s_cmp_gt_u32 s42, 512
    s_cbranch_scc1 L_k1_kernel_r2_done
    s_lshl_b32 s44, s42, 13
    s_add_u32 s44, s44, s43
    buffer_store_dword v20, v11, s[32:35], s44 offen sc1
    s_add_u32 s42, s42, 1
    s_waitcnt lgkmcnt(10)
    s_cmp_gt_u32 s42, 512
    s_cbranch_scc1 L_k1_kernel_r2_done
    s_lshl_b32 s44, s42, 13
    s_add_u32 s44, s44, s43
    buffer_store_dword v21, v11, s[32:35], s44 offen sc1
    s_add_u32 s42, s42, 1
    s_waitcnt lgkmcnt(9)
    s_cmp_gt_u32 s42, 512
    s_cbranch_scc1 L_k1_kernel_r2_done
    s_lshl_b32 s44, s42, 13
    s_add_u32 s44, s44, s43
    buffer_store_dword v22, v11, s[32:35], s44 offen sc1
    s_add_u32 s42, s42, 1
    s_waitcnt lgkmcnt(8)
    s_cmp_gt_u32 s42, 512
    s_cbranch_scc1 L_k1_kernel_r2_done
    s_lshl_b32 s44, s42, 13
    s_add_u32 s44, s44, s43
    buffer_store_dword v23, v11, s[32:35], s44 offen sc1
    s_add_u32 s42, s42, 1
    s_waitcnt lgkmcnt(7)
    s_cmp_gt_u32 s42, 512
    s_cbranch_scc1 L_k1_kernel_r2_done
    s_lshl_b32 s44, s42, 13
    s_add_u32 s44, s44, s43
    buffer_store_dword v24, v11, s[32:35], s44 offen sc1
    s_add_u32 s42, s42, 1
    s_waitcnt lgkmcnt(6)
    s_cmp_gt_u32 s42, 512
    s_cbranch_scc1 L_k1_kernel_r2_done
    s_lshl_b32 s44, s42, 13
    s_add_u32 s44, s44, s43
    buffer_store_dword v25, v11, s[32:35], s44 offen sc1
    s_add_u32 s42, s42, 1
    s_waitcnt lgkmcnt(5)
    s_cmp_gt_u32 s42, 512
    s_cbranch_scc1 L_k1_kernel_r2_done
    s_lshl_b32 s44, s42, 13
    s_add_u32 s44, s44, s43
    buffer_store_dword v26, v11, s[32:35], s44 offen sc1
    s_add_u32 s42, s42, 1
    s_waitcnt lgkmcnt(4)
    s_cmp_gt_u32 s42, 512
    s_cbranch_scc1 L_k1_kernel_r2_done
    s_lshl_b32 s44, s42, 13
    s_add_u32 s44, s44, s43
    buffer_store_dword v27, v11, s[32:35], s44 offen sc1
    s_add_u32 s42, s42, 1
    s_waitcnt lgkmcnt(3)
    s_cmp_gt_u32 s42, 512
    s_cbranch_scc1 L_k1_kernel_r2_done
    s_lshl_b32 s44, s42, 13
    s_add_u32 s44, s44, s43
    buffer_store_dword v28, v11, s[32:35], s44 offen sc1
    s_add_u32 s42, s42, 1
    s_waitcnt lgkmcnt(2)
    s_cmp_gt_u32 s42, 512
    s_cbranch_scc1 L_k1_kernel_r2_done
    s_lshl_b32 s44, s42, 13
    s_add_u32 s44, s44, s43
    buffer_store_dword v29, v11, s[32:35], s44 offen sc1
    s_add_u32 s42, s42, 1
    s_waitcnt lgkmcnt(1)
    s_cmp_gt_u32 s42, 512
    s_cbranch_scc1 L_k1_kernel_r2_done
    s_lshl_b32 s44, s42, 13
    s_add_u32 s44, s44, s43
    buffer_store_dword v30, v11, s[32:35], s44 offen sc1
    s_add_u32 s42, s42, 1
    s_waitcnt lgkmcnt(0)
    s_cmp_gt_u32 s42, 512
    s_cbranch_scc1 L_k1_kernel_r2_done
    s_lshl_b32 s44, s42, 13
    s_add_u32 s44, s44, s43
    buffer_store_dword v31, v11, s[32:35], s44 offen sc1
    s_add_u32 s42, s42, 1
L_k1_kernel_r2_done:
    s_endpgm
.p2align 6
L_k1_kernel_r3:
    s_mov_b32 s57, 68681728
    s_load_dwordx2 s[4:5], s[0:1], 24
    s_load_dwordx2 s[28:29], s[0:1], 96
    s_and_b32 s16, s2, 15
    s_lshr_b32 s17, s2, 4
    v_lshrrev_b32 v1, 3, v0
    v_and_b32 v2, 7, v0
    v_lshlrev_b32 v3, 11, v1
    v_lshl_add_u32 v3, v2, 4, v3
    s_lshl_b32 s18, s16, 18
    s_lshl_b32 s19, s17, 7
    s_add_u32 s18, s18, s19
    s_waitcnt lgkmcnt(0)
    s_mov_b32 s8, s4
    s_mov_b32 s9, s5
    s_mov_b32 s10, 4194304
    s_mov_b32 s11, 0x00020000
    s_mov_b32 s32, s28
    s_mov_b32 s33, s29
    s_mov_b32 s34, 268435456
    s_mov_b32 s35, 0x00020000
    buffer_load_dwordx4 v[16:19], v3, s[8:11], s18 offen
    s_add_u32 s18, s18, 65536
    buffer_load_dwordx4 v[20:23], v3, s[8:11], s18 offen
    s_add_u32 s18, s18, 65536
    buffer_load_dwordx4 v[24:27], v3, s[8:11], s18 offen
    s_add_u32 s18, s18, 65536
    buffer_load_dwordx4 v[28:31], v3, s[8:11], s18 offen
    v_lshlrev_b32 v4, 7, v1
    v_lshrrev_b32 v5, 3, v1
    v_lshl_add_u32 v4, v5, 4, v4
    v_lshl_add_u32 v4, v2, 4, v4
    s_waitcnt vmcnt(3)
    ds_write_b128 v4, v[16:19] offset:0
    s_waitcnt vmcnt(2)
    ds_write_b128 v4, v[20:23] offset:4160
    s_waitcnt vmcnt(1)
    ds_write_b128 v4, v[24:27] offset:8320
    s_waitcnt vmcnt(0)
    ds_write_b128 v4, v[28:31] offset:12480
    v_and_b32 v6, 15, v0
    v_lshrrev_b32 v7, 4, v0
    v_mul_u32_u24 v8, 1040, v6
    v_lshl_add_u32 v8, v7, 1, v8
    s_waitcnt lgkmcnt(0)
    s_barrier
    ds_read_u16_d16 v32, v8 offset:896
    ds_read_u16_d16_hi v48, v8 offset:768
    ds_read_u16_d16 v33, v8 offset:640
    ds_read_u16_d16_hi v49, v8 offset:512
    ds_read_u16_d16 v34, v8 offset:384
    ds_read_u16_d16_hi v50, v8 offset:256
    ds_read_u16_d16 v35, v8 offset:128
    ds_read_u16_d16_hi v51, v8 offset:0
    ds_read_u16_d16 v36, v8 offset:928
    ds_read_u16_d16_hi v52, v8 offset:800
    ds_read_u16_d16 v37, v8 offset:672
    ds_read_u16_d16_hi v53, v8 offset:544
    ds_read_u16_d16 v38, v8 offset:416
    ds_read_u16_d16_hi v54, v8 offset:288
    ds_read_u16_d16 v39, v8 offset:160
    ds_read_u16_d16_hi v55, v8 offset:32
    ds_read_u16_d16 v40, v8 offset:960
    ds_read_u16_d16_hi v56, v8 offset:832
    ds_read_u16_d16 v41, v8 offset:704
    ds_read_u16_d16_hi v57, v8 offset:576
    ds_read_u16_d16 v42, v8 offset:448
    ds_read_u16_d16_hi v58, v8 offset:320
    ds_read_u16_d16 v43, v8 offset:192
    ds_read_u16_d16_hi v59, v8 offset:64
    ds_read_u16_d16 v44, v8 offset:992
    ds_read_u16_d16_hi v60, v8 offset:864
    ds_read_u16_d16 v45, v8 offset:736
    ds_read_u16_d16_hi v61, v8 offset:608
    ds_read_u16_d16 v46, v8 offset:480
    ds_read_u16_d16_hi v62, v8 offset:352
    ds_read_u16_d16 v47, v8 offset:224
    ds_read_u16_d16_hi v63, v8 offset:96
    v_lshlrev_b32 v9, 12, v7
    v_lshl_add_u32 v9, v6, 4, v9
    s_lshl_b32 s18, s17, 18
    s_lshl_b32 s19, s16, 8
    s_add_u32 s18, s18, s19
    s_add_u32 s18, s18, 41943040
    s_waitcnt lgkmcnt(15)
    s_waitcnt lgkmcnt(15)
    v_or_b32 v32, v32, v48
    v_or_b32 v33, v33, v49
    v_or_b32 v34, v34, v50
    v_or_b32 v35, v35, v51
    buffer_store_dwordx4 v[32:35], v9, s[32:35], s18 offen sc1
    s_add_u32 s18, s18, 65536
    s_waitcnt lgkmcnt(15)
    s_waitcnt lgkmcnt(15)
    v_or_b32 v36, v36, v52
    v_or_b32 v37, v37, v53
    v_or_b32 v38, v38, v54
    v_or_b32 v39, v39, v55
    buffer_store_dwordx4 v[36:39], v9, s[32:35], s18 offen sc1
    s_add_u32 s18, s18, 65536
    s_waitcnt lgkmcnt(8)
    v_or_b32 v40, v40, v56
    v_or_b32 v41, v41, v57
    v_or_b32 v42, v42, v58
    v_or_b32 v43, v43, v59
    buffer_store_dwordx4 v[40:43], v9, s[32:35], s18 offen sc1
    s_add_u32 s18, s18, 65536
    s_waitcnt lgkmcnt(0)
    v_or_b32 v44, v44, v60
    v_or_b32 v45, v45, v61
    v_or_b32 v46, v46, v62
    v_or_b32 v47, v47, v63
    buffer_store_dwordx4 v[44:47], v9, s[32:35], s18 offen sc1
    s_endpgm
.globl k2_kernel
.p2align 8
.type k2_kernel,@function
k2_kernel:
    s_mov_b32 s94, s2
    s_cmp_lt_u32 s2, 256
    s_cbranch_scc1 L_k2_kernel_r0
    s_sub_u32 s2, s2, 256
    s_cmp_lt_u32 s2, 512
    s_cbranch_scc1 L_k2_kernel_r1
    s_sub_u32 s2, s2, 512
    s_endpgm
.p2align 6
L_k2_kernel_r0:
    s_mov_b32 s57, 71303168
    s_load_dwordx2 s[28:29], s[0:1], 96
    s_and_b32 s16, s2, 7
    s_lshr_b32 s17, s2, 3
    s_lshr_b32 s18, s17, 2
    s_lshl_b32 s18, s18, 3
    s_add_u32 s16, s16, s18
    s_lshl_b32 s16, s16, 2
    s_and_b32 s17, s17, 3
    s_add_u32 s16, s16, s17
    s_cmp_lt_u32 s2, 256
    s_cselect_b32 s2, s16, s2
    s_mov_b32 s20, 0x3f6c835e
    s_mov_b32 s21, 0xbec3ef15
    s_mov_b32 s22, 0x3f3504f3
    s_mov_b32 s23, 0xbf3504f3
    s_mov_b32 s24, 0x3ec3ef15
    s_mov_b32 s25, 0xbf6c835e
    v_lshrrev_b32 v1, 7, v0
    v_and_b32 v2, 127, v0
    s_nop 0
    v_readfirstlane_b32 s30, v1
    s_sub_u32 s16, 512, s2
    s_cmp_eq_u32 s2, 0
    s_cselect_b32 s46, 1, 0
    s_cselect_b32 s17, 256, s16
    s_cmp_eq_u32 s30, 0
    s_cselect_b32 s18, s2, s17
    s_lshr_b32 s19, s18, 2
    s_mul_i32 s19, s19, 32768
    s_and_b32 s31, s18, 3
    s_lshl_b32 s31, s31, 2
    s_add_u32 s19, s19, s31
    s_add_u32 s19, s19, 0
    v_lshlrev_b32 v3, 4, v2
    s_waitcnt lgkmcnt(0)
    s_mov_b32 s12, s28
    s_mov_b32 s13, s29
    s_mov_b32 s14, 268435456
    s_mov_b32 s15, 0x00020000
    buffer_load_dword v81, v3, s[12:15], s19 offen offset:0
    buffer_load_dword v83, v3, s[12:15], s19 offen offset:2048
    s_add_u32 s19, s19, 4096
    buffer_load_dword v85, v3, s[12:15], s19 offen offset:0
    buffer_load_dword v87, v3, s[12:15], s19 offen offset:2048
    s_add_u32 s19, s19, 4096
    buffer_load_dword v89, v3, s[12:15], s19 offen offset:0
    buffer_load_dword v91, v3, s[12:15], s19 offen offset:2048
    s_add_u32 s19, s19, 4096
    buffer_load_dword v93, v3, s[12:15], s19 offen offset:0
    buffer_load_dword v95, v3, s[12:15], s19 offen offset:2048
    s_add_u32 s19, s19, 4096
    buffer_load_dword v97, v3, s[12:15], s19 offen offset:0
    buffer_load_dword v99, v3, s[12:15], s19 offen offset:2048
    s_add_u32 s19, s19, 4096
    buffer_load_dword v101, v3, s[12:15], s19 offen offset:0
    buffer_load_dword v103, v3, s[12:15], s19 offen offset:2048
    s_add_u32 s19, s19, 4096
    buffer_load_dword v105, v3, s[12:15], s19 offen offset:0
    buffer_load_dword v107, v3, s[12:15], s19 offen offset:2048
    s_add_u32 s19, s19, 4096
    buffer_load_dword v109, v3, s[12:15], s19 offen offset:0
    buffer_load_dword v111, v3, s[12:15], s19 offen offset:2048
    v_lshlrev_b32 v14, 2, v0
    v_sub_u32 v15, 1024, v14
    v_sub_u32 v16, 8192, v14
    v_and_b32 v16, 8191, v16
    s_lshl_b32 s36, s2, 13
    s_add_u32 s36, s36, 33554432
    s_add_u32 s37, s36, 4096
    s_lshl_b32 s38, s16, 13
    s_add_u32 s38, s38, 33554432
    s_add_u32 s39, s38, 4096
    buffer_load_dword v140, v14, s[12:15], s36 offen offset:0
    buffer_load_dword v141, v14, s[12:15], s36 offen offset:1024
    buffer_load_dword v142, v14, s[12:15], s36 offen offset:2048
    buffer_load_dword v143, v14, s[12:15], s36 offen offset:3072
    buffer_load_dword v144, v14, s[12:15], s37 offen offset:0
    buffer_load_dword v145, v14, s[12:15], s37 offen offset:1024
    buffer_load_dword v146, v14, s[12:15], s37 offen offset:2048
    buffer_load_dword v147, v14, s[12:15], s37 offen offset:3072
    buffer_load_dword v148, v16, s[12:15], s38 offen
    buffer_load_dword v149, v15, s[12:15], s39 offen offset:2048
    buffer_load_dword v150, v15, s[12:15], s39 offen offset:1024
    buffer_load_dword v151, v15, s[12:15], s39 offen offset:0
    buffer_load_dword v152, v15, s[12:15], s38 offen offset:3072
    buffer_load_dword v153, v15, s[12:15], s38 offen offset:2048
    buffer_load_dword v154, v15, s[12:15], s38 offen offset:1024
    buffer_load_dword v155, v15, s[12:15], s38 offen offset:0
    s_cmp_eq_u32 s46, 0
    s_cbranch_scc1 L_k2_kernel_r0_nox
    buffer_load_dword v28, v14, s[12:15], s38 offen offset:0
    buffer_load_dword v29, v14, s[12:15], s38 offen offset:1024
    buffer_load_dword v30, v14, s[12:15], s38 offen offset:2048
    buffer_load_dword v31, v14, s[12:15], s38 offen offset:3072
    buffer_load_dword v32, v14, s[12:15], s39 offen offset:0
    buffer_load_dword v33, v14, s[12:15], s39 offen offset:1024
    buffer_load_dword v34, v14, s[12:15], s39 offen offset:2048
    buffer_load_dword v35, v14, s[12:15], s39 offen offset:3072
    buffer_load_dword v20, v16, s[12:15], s36 offen
    buffer_load_dword v21, v15, s[12:15], s37 offen offset:2048
    buffer_load_dword v22, v15, s[12:15], s37 offen offset:1024
    buffer_load_dword v23, v15, s[12:15], s37 offen offset:0
    buffer_load_dword v24, v15, s[12:15], s36 offen offset:3072
    buffer_load_dword v25, v15, s[12:15], s36 offen offset:2048
    buffer_load_dword v26, v15, s[12:15], s36 offen offset:1024
    buffer_load_dword v27, v15, s[12:15], s36 offen offset:0
L_k2_kernel_r0_nox:
    v_cvt_f32_u32 v4, v2
    v_mul_f32 v4, 0x3a000000, v4
    v_cos_f32 v42, v4
    v_sin_f32_e64 v43, -v4
    v_mul_f32 v45, 0x40000000, v4
    v_cos_f32 v44, v45
    v_sin_f32_e64 v45, -v45
    v_mul_f32 v47, 0x40400000, v4
    v_cos_f32 v46, v47
    v_sin_f32_e64 v47, -v47
    v_mul_f32 v49, 0x40800000, v4
    v_cos_f32 v48, v49
    v_sin_f32_e64 v49, -v49
    v_mul_f32 v51, 0x40a00000, v4
    v_cos_f32 v50, v51
    v_sin_f32_e64 v51, -v51
    v_mul_f32 v53, 0x40c00000, v4
    v_cos_f32 v52, v53
    v_sin_f32_e64 v53, -v53
    v_mul_f32 v55, 0x40e00000, v4
    v_cos_f32 v54, v55
    v_sin_f32_e64 v55, -v55
    v_mul_f32 v57, 0x41000000, v4
    v_cos_f32 v56, v57
    v_sin_f32_e64 v57, -v57
    v_mul_f32 v59, 0x41100000, v4
    v_cos_f32 v58, v59
    v_sin_f32_e64 v59, -v59
    v_mul_f32 v61, 0x41200000, v4
    v_cos_f32 v60, v61
    v_sin_f32_e64 v61, -v61
    v_mul_f32 v63, 0x41300000, v4
    v_cos_f32 v62, v63
    v_sin_f32_e64 v63, -v63
    v_mul_f32 v65, 0x41400000, v4
    v_cos_f32 v64, v65
    v_sin_f32_e64 v65, -v65
    v_mul_f32 v67, 0x41500000, v4
    v_cos_f32 v66, v67
    v_sin_f32_e64 v67, -v67
    v_mul_f32 v69, 0x41600000, v4
    v_cos_f32 v68, v69
    v_sin_f32_e64 v69, -v69
    v_mul_f32 v71, 0x41700000, v4
    v_cos_f32 v70, v71
    v_sin_f32_e64 v71, -v71
    v_mul_u32_u24 v9, 2176, v1
    v_add_u32 v5, v9, v2
    v_lshlrev_b32 v5, 3, v5
    v_lshrrev_b32 v6, 3, v2
    v_and_b32 v7, 7, v2
    v_mul_u32_u24 v8, 136, v6
    v_add3_u32 v8, v8, v9, v7
    v_lshlrev_b32 v8, 3, v8
    v_mul_u32_u24 v9, 2560, v1
    v_mul_u32_u24 v10, 10, v6
    v_add3_u32 v10, v10, v9, v7
    v_lshlrev_b32 v10, 3, v10
    v_mul_u32_u24 v11, 80, v0
    v_sub_u32 v13, 256, v0
    v_and_b32 v13, 255, v13
    v_mul_u32_u24 v13, 80, v13
    s_mov_b32 s47, 20480
    s_cmp_eq_u32 s46, 1
    s_cselect_b32 s47, 0, s47
    v_add_u32 v13, s47, v13
    v_cvt_f32_u32 v12, v7
    v_mul_f32 v17, 0x3e000000, v12
    v_add_u32 v18, -128, v0
    s_lshl_b32 s47, s46, 3
    s_sub_u32 s47, 8, s47
    v_cmp_gt_u32 vcc, s47, v18
    s_nop 1
    v_cndmask_b32 v17, 0, v17, vcc
    v_cos_f32 v72, v17
    v_sin_f32_e64 v73, -v17
    v_mul_f32 v12, 0x3c000000, v12
    v_cvt_f32_u32 v17, s2
    v_mul_f32 v17, 0x3a800000, v17
    v_cos_f32 v18, v17
    v_sin_f32_e64 v19, -v17
    s_nop 0
    v_readfirstlane_b32 s44, v18
    v_readfirstlane_b32 s45, v19
    s_waitcnt vmcnt(16)
    v_lshlrev_b32 v80, 16, v81
    v_and_b32 v81, 0xffff0000, v81
    v_lshlrev_b32 v82, 16, v83
    v_and_b32 v83, 0xffff0000, v83
    v_lshlrev_b32 v84, 16, v85
    v_and_b32 v85, 0xffff0000, v85
    v_lshlrev_b32 v86, 16, v87
    v_and_b32 v87, 0xffff0000, v87
    v_lshlrev_b32 v88, 16, v89
    v_and_b32 v89, 0xffff0000, v89
    v_lshlrev_b32 v90, 16, v91
    v_and_b32 v91, 0xffff0000, v91
    v_lshlrev_b32 v92, 16, v93
    v_and_b32 v93, 0xffff0000, v93
    v_lshlrev_b32 v94, 16, v95
    v_and_b32 v95, 0xffff0000, v95
    v_lshlrev_b32 v96, 16, v97
    v_and_b32 v97, 0xffff0000, v97
    v_lshlrev_b32 v98, 16, v99
    v_and_b32 v99, 0xffff0000, v99
    v_lshlrev_b32 v100, 16, v101
    v_and_b32 v101, 0xffff0000, v101
    v_lshlrev_b32 v102, 16, v103
    v_and_b32 v103, 0xffff0000, v103
    v_lshlrev_b32 v104, 16, v105
    v_and_b32 v105, 0xffff0000, v105
    v_lshlrev_b32 v106, 16, v107
    v_and_b32 v107, 0xffff0000, v107
    v_lshlrev_b32 v108, 16, v109
    v_and_b32 v109, 0xffff0000, v109
    v_lshlrev_b32 v110, 16, v111
    v_and_b32 v111, 0xffff0000, v111
    v_pk_add_f32 v[112:113], v[80:81], v[96:97] neg_lo:[0,1] neg_hi:[0,1]
    v_pk_add_f32 v[80:81], v[80:81], v[96:97]
    v_pk_add_f32 v[96:97], v[88:89], v[104:105] neg_lo:[0,1] neg_hi:[0,1]
    v_pk_add_f32 v[88:89], v[88:89], v[104:105]
    v_pk_add_f32 v[104:105], v[80:81], v[88:89] neg_lo:[0,1] neg_hi:[0,1]
    v_pk_add_f32 v[80:81], v[80:81], v[88:89]
    v_pk_add_f32 v[88:89], v[112:113], v[96:97] op_sel:[0,1] op_sel_hi:[1,0] neg_hi:[0,1]
    v_pk_add_f32 v[112:113], v[112:113], v[96:97] op_sel:[0,1] op_sel_hi:[1,0] neg_lo:[0,1]
    v_pk_add_f32 v[114:115], v[82:83], v[98:99] neg_lo:[0,1] neg_hi:[0,1]
    v_pk_add_f32 v[82:83], v[82:83], v[98:99]
    v_pk_add_f32 v[98:99], v[90:91], v[106:107] neg_lo:[0,1] neg_hi:[0,1]
    v_pk_add_f32 v[90:91], v[90:91], v[106:107]
    v_pk_add_f32 v[106:107], v[82:83], v[90:91] neg_lo:[0,1] neg_hi:[0,1]
    v_pk_add_f32 v[82:83], v[82:83], v[90:91]
    v_pk_add_f32 v[90:91], v[114:115], v[98:99] op_sel:[0,1] op_sel_hi:[1,0] neg_hi:[0,1]
    v_pk_add_f32 v[114:115], v[114:115], v[98:99] op_sel:[0,1] op_sel_hi:[1,0] neg_lo:[0,1]
    v_pk_mul_f32 v[116:117], v[90:91], s[20:21] op_sel:[0,0] op_sel_hi:[1,0]
    v_pk_fma_f32 v[90:91], v[90:91], s[20:21], v[116:117] op_sel:[1,1,0] op_sel_hi:[0,1,1] neg_lo:[0,1,0]
    v_pk_mul_f32 v[118:119], v[106:107], s[22:23] op_sel:[0,0] op_sel_hi:[1,0]
    v_pk_fma_f32 v[106:107], v[106:107], s[22:23], v[118:119] op_sel:[1,1,0] op_sel_hi:[0,1,1] neg_lo:[0,1,0]
    v_pk_mul_f32 v[120:121], v[114:115], s[24:25] op_sel:[0,0] op_sel_hi:[1,0]
    v_pk_fma_f32 v[114:115], v[114:115], s[24:25], v[120:121] op_sel:[1,1,0] op_sel_hi:[0,1,1] neg_lo:[0,1,0]
    v_pk_add_f32 v[122:123], v[84:85], v[100:101] neg_lo:[0,1] neg_hi:[0,1]
    v_pk_add_f32 v[84:85], v[84:85], v[100:101]
    v_pk_add_f32 v[100:101], v[92:93], v[108:109] neg_lo:[0,1] neg_hi:[0,1]
    v_pk_add_f32 v[92:93], v[92:93], v[108:109]
    v_pk_add_f32 v[108:109], v[84:85], v[92:93] neg_lo:[0,1] neg_hi:[0,1]
    v_pk_add_f32 v[84:85], v[84:85], v[92:93]
    v_pk_add_f32 v[92:93], v[122:123], v[100:101] op_sel:[0,1] op_sel_hi:[1,0] neg_hi:[0,1]
    v_pk_add_f32 v[122:123], v[122:123], v[100:101] op_sel:[0,1] op_sel_hi:[1,0] neg_lo:[0,1]
    v_pk_mul_f32 v[124:125], v[92:93], s[22:23] op_sel:[0,0] op_sel_hi:[1,0]
    v_pk_fma_f32 v[92:93], v[92:93], s[22:23], v[124:125] op_sel:[1,1,0] op_sel_hi:[0,1,1] neg_lo:[0,1,0]
    v_pk_mul_f32 v[126:127], v[122:123], s[22:23] op_sel:[0,0] op_sel_hi:[1,0]
    v_pk_fma_f32 v[122:123], v[122:123], s[22:23], v[126:127] op_sel:[1,1,0] op_sel_hi:[0,1,1] neg_lo:[0,1,0]
    v_pk_add_f32 v[128:129], v[86:87], v[102:103] neg_lo:[0,1] neg_hi:[0,1]
    v_pk_add_f32 v[86:87], v[86:87], v[102:103]
    v_pk_add_f32 v[102:103], v[94:95], v[110:111] neg_lo:[0,1] neg_hi:[0,1]
    v_pk_add_f32 v[94:95], v[94:95], v[110:111]
    v_pk_add_f32 v[110:111], v[86:87], v[94:95] neg_lo:[0,1] neg_hi:[0,1]
    v_pk_add_f32 v[86:87], v[86:87], v[94:95]
    v_pk_add_f32 v[94:95], v[128:129], v[102:103] op_sel:[0,1] op_sel_hi:[1,0] neg_hi:[0,1]
    v_pk_add_f32 v[128:129], v[128:129], v[102:103] op_sel:[0,1] op_sel_hi:[1,0] neg_lo:[0,1]
    v_pk_mul_f32 v[130:131], v[94:95], s[24:25] op_sel:[0,0] op_sel_hi:[1,0]
    v_pk_fma_f32 v[94:95], v[94:95], s[24:25], v[130:131] op_sel:[1,1,0] op_sel_hi:[0,1,1] neg_lo:[0,1,0]
    v_pk_mul_f32 v[132:133], v[110:111], s[22:23] op_sel:[0,0] op_sel_hi:[1,0]
    v_pk_fma_f32 v[110:111], v[110:111], s[22:23], v[132:133] op_sel:[1,1,0] op_sel_hi:[0,1,1] neg_lo:[0,1,0]
    v_pk_mul_f32 v[134:135], v[128:129], s[20:21] op_sel:[0,0] op_sel_hi:[1,0]
    v_pk_fma_f32 v[128:129], v[128:129], s[20:21], v[134:135] op_sel:[1,1,0] op_sel_hi:[0,1,1] neg_lo:[0,1,0]
    v_pk_add_f32 v[136:137], v[80:81], v[84:85] neg_lo:[0,1] neg_hi:[0,1]
    v_pk_add_f32 v[80:81], v[80:81], v[84:85]
    v_pk_add_f32 v[84:85], v[82:83], v[86:87] neg_lo:[0,1] neg_hi:[0,1]
    v_pk_add_f32 v[82:83], v[82:83], v[86:87]
    v_pk_add_f32 v[86:87], v[80:81], v[82:83] neg_lo:[0,1] neg_hi:[0,1]
    v_pk_add_f32 v[80:81], v[80:81], v[82:83]
    v_pk_add_f32 v[82:83], v[136:137], v[84:85] op_sel:[0,1] op_sel_hi:[1,0] neg_hi:[0,1]
    v_pk_add_f32 v[136:137], v[136:137], v[84:85] op_sel:[0,1] op_sel_hi:[1,0] neg_lo:[0,1]
    v_pk_add_f32 v[138:139], v[88:89], v[92:93] neg_lo:[0,1] neg_hi:[0,1]
    v_pk_add_f32 v[88:89], v[88:89], v[92:93]
    v_pk_add_f32 v[92:93], v[90:91], v[94:95] neg_lo:[0,1] neg_hi:[0,1]
    v_pk_add_f32 v[90:91], v[90:91], v[94:95]
    v_pk_add_f32 v[94:95], v[88:89], v[90:91] neg_lo:[0,1] neg_hi:[0,1]
    v_pk_add_f32 v[88:89], v[88:89], v[90:91]
    v_pk_add_f32 v[90:91], v[138:139], v[92:93] op_sel:[0,1] op_sel_hi:[1,0] neg_hi:[0,1]
    v_pk_add_f32 v[138:139], v[138:139], v[92:93] op_sel:[0,1] op_sel_hi:[1,0] neg_lo:[0,1]
    v_pk_add_f32 v[96:97], v[104:105], v[108:109] op_sel:[0,1] op_sel_hi:[1,0] neg_lo:[0,1]
    v_pk_add_f32 v[104:105], v[104:105], v[108:109] op_sel:[0,1] op_sel_hi:[1,0] neg_hi:[0,1]
    v_pk_add_f32 v[108:109], v[106:107], v[110:111] op_sel:[0,1] op_sel_hi:[1,0] neg_lo:[0,1]
    v_pk_add_f32 v[106:107], v[106:107], v[110:111] op_sel:[0,1] op_sel_hi:[1,0] neg_hi:[0,1]
    v_pk_add_f32 v[110:111], v[104:105], v[106:107] neg_lo:[0,1] neg_hi:[0,1]
    v_pk_add_f32 v[104:105], v[104:105], v[106:107]
    v_pk_add_f32 v[106:107], v[96:97], v[108:109] op_sel:[0,1] op_sel_hi:[1,0] neg_hi:[0,1]
    v_pk_add_f32 v[96:97], v[96:97], v[108:109] op_sel:[0,1] op_sel_hi:[1,0] neg_lo:[0,1]
    v_pk_add_f32 v[98:99], v[112:113], v[122:123] op_sel:[0,1] op_sel_hi:[1,0] neg_lo:[0,1]
    v_pk_add_f32 v[112:113], v[112:113], v[122:123] op_sel:[0,1] op_sel_hi:[1,0] neg_hi:[0,1]
    v_pk_add_f32 v[122:123], v[114:115], v[128:129]
    v_pk_add_f32 v[114:115], v[114:115], v[128:129] neg_lo:[0,1] neg_hi:[0,1]
    v_pk_add_f32 v[128:129], v[112:113], v[114:115] neg_lo:[0,1] neg_hi:[0,1]
    v_pk_add_f32 v[112:113], v[112:113], v[114:115]
    v_pk_add_f32 v[114:115], v[98:99], v[122:123] op_sel:[0,1] op_sel_hi:[1,0] neg_hi:[0,1]
    v_pk_add_f32 v[98:99], v[98:99], v[122:123] op_sel:[0,1] op_sel_hi:[1,0] neg_lo:[0,1]
    ds_write_b64 v5, v[80:81] offset:0
    v_pk_mul_f32 v[116:117], v[88:89], v[42:43] op_sel:[0,0] op_sel_hi:[1,0]
    v_pk_fma_f32 v[88:89], v[88:89], v[42:43], v[116:117] op_sel:[1,1,0] op_sel_hi:[0,1,1] neg_lo:[0,1,0]
    ds_write_b64 v5, v[88:89] offset:1088
    v_pk_mul_f32 v[118:119], v[104:105], v[44:45] op_sel:[0,0] op_sel_hi:[1,0]
    v_pk_fma_f32 v[104:105], v[104:105], v[44:45], v[118:119] op_sel:[1,1,0] op_sel_hi:[0,1,1] neg_lo:[0,1,0]
    ds_write_b64 v5, v[104:105] offset:2176
    v_pk_mul_f32 v[120:121], v[112:113], v[46:47] op_sel:[0,0] op_sel_hi:[1,0]
    v_pk_fma_f32 v[112:113], v[112:113], v[46:47], v[120:121] op_sel:[1,1,0] op_sel_hi:[0,1,1] neg_lo:[0,1,0]
    ds_write_b64 v5, v[112:113] offset:3264
    v_pk_mul_f32 v[100:101], v[82:83], v[48:49] op_sel:[0,0] op_sel_hi:[1,0]
    v_pk_fma_f32 v[82:83], v[82:83], v[48:49], v[100:101] op_sel:[1,1,0] op_sel_hi:[0,1,1] neg_lo:[0,1,0]
    ds_write_b64 v5, v[82:83] offset:4352
    v_pk_mul_f32 v[124:125], v[90:91], v[50:51] op_sel:[0,0] op_sel_hi:[1,0]
    v_pk_fma_f32 v[90:91], v[90:91], v[50:51], v[124:125] op_sel:[1,1,0] op_sel_hi:[0,1,1] neg_lo:[0,1,0]
    ds_write_b64 v5, v[90:91] offset:5440
    v_pk_mul_f32 v[126:127], v[106:107], v[52:53] op_sel:[0,0] op_sel_hi:[1,0]
    v_pk_fma_f32 v[106:107], v[106:107], v[52:53], v[126:127] op_sel:[1,1,0] op_sel_hi:[0,1,1] neg_lo:[0,1,0]
    ds_write_b64 v5, v[106:107] offset:6528
    v_pk_mul_f32 v[102:103], v[114:115], v[54:55] op_sel:[0,0] op_sel_hi:[1,0]
    v_pk_fma_f32 v[114:115], v[114:115], v[54:55], v[102:103] op_sel:[1,1,0] op_sel_hi:[0,1,1] neg_lo:[0,1,0]
    ds_write_b64 v5, v[114:115] offset:7616
    v_pk_mul_f32 v[130:131], v[86:87], v[56:57] op_sel:[0,0] op_sel_hi:[1,0]
    v_pk_fma_f32 v[86:87], v[86:87], v[56:57], v[130:131] op_sel:[1,1,0] op_sel_hi:[0,1,1] neg_lo:[0,1,0]
    ds_write_b64 v5, v[86:87] offset:8704
    v_pk_mul_f32 v[132:133], v[94:95], v[58:59] op_sel:[0,0] op_sel_hi:[1,0]
    v_pk_fma_f32 v[94:95], v[94:95], v[58:59], v[132:133] op_sel:[1,1,0] op_sel_hi:[0,1,1] neg_lo:[0,1,0]
    ds_write_b64 v5, v[94:95] offset:9792
    v_pk_mul_f32 v[134:135], v[110:111], v[60:61] op_sel:[0,0] op_sel_hi:[1,0]
    v_pk_fma_f32 v[110:111], v[110:111], v[60:61], v[134:135] op_sel:[1,1,0] op_sel_hi:[0,1,1] neg_lo:[0,1,0]
    ds_write_b64 v5, v[110:111] offset:10880
    v_pk_mul_f32 v[84:85], v[128:129], v[62:63] op_sel:[0,0] op_sel_hi:[1,0]
    v_pk_fma_f32 v[128:129], v[128:129], v[62:63], v[84:85] op_sel:[1,1,0] op_sel_hi:[0,1,1] neg_lo:[0,1,0]
    ds_write_b64 v5, v[128:129] offset:11968
    v_pk_mul_f32 v[92:93], v[136:137], v[64:65] op_sel:[0,0] op_sel_hi:[1,0]
    v_pk_fma_f32 v[136:137], v[136:137], v[64:65], v[92:93] op_sel:[1,1,0] op_sel_hi:[0,1,1] neg_lo:[0,1,0]
    ds_write_b64 v5, v[136:137] offset:13056
    v_pk_mul_f32 v[108:109], v[138:139], v[66:67] op_sel:[0,0] op_sel_hi:[1,0]
    v_pk_fma_f32 v[138:139], v[138:139], v[66:67], v[108:109] op_sel:[1,1,0] op_sel_hi:[0,1,1] neg_lo:[0,1,0]
    ds_write_b64 v5, v[138:139] offset:14144
    v_pk_mul_f32 v[122:123], v[96:97], v[68:69] op_sel:[0,0] op_sel_hi:[1,0]
    v_pk_fma_f32 v[96:97], v[96:97], v[68:69], v[122:123] op_sel:[1,1,0] op_sel_hi:[0,1,1] neg_lo:[0,1,0]
    ds_write_b64 v5, v[96:97] offset:15232
    v_pk_mul_f32 v[80:81], v[98:99], v[70:71] op_sel:[0,0] op_sel_hi:[1,0]
    v_pk_fma_f32 v[98:99], v[98:99], v[70:71], v[80:81] op_sel:[1,1,0] op_sel_hi:[0,1,1] neg_lo:[0,1,0]
    ds_write_b64 v5, v[98:99] offset:16320
    v_cos_f32 v42, v12
    v_sin_f32_e64 v43, -v12
    v_mul_f32 v45, 0x40000000, v12
    v_cos_f32 v44, v45
    v_sin_f32_e64 v45, -v45
    v_mul_f32 v47, 0x40400000, v12
    v_cos_f32 v46, v47
    v_sin_f32_e64 v47, -v47
    v_mul_f32 v49, 0x40800000, v12
    v_cos_f32 v48, v49
    v_sin_f32_e64 v49, -v49
    v_mul_f32 v51, 0x40a00000, v12
    v_cos_f32 v50, v51
    v_sin_f32_e64 v51, -v51
    v_mul_f32 v53, 0x40c00000, v12
    v_cos_f32 v52, v53
    v_sin_f32_e64 v53, -v53
    v_mul_f32 v55, 0x40e00000, v12
    v_cos_f32 v54, v55
    v_sin_f32_e64 v55, -v55
    v_mul_f32 v57, 0x41000000, v12
    v_cos_f32 v56, v57
    v_sin_f32_e64 v57, -v57
    v_mul_f32 v59, 0x41100000, v12
    v_cos_f32 v58, v59
    v_sin_f32_e64 v59, -v59
    v_mul_f32 v61, 0x41200000, v12
    v_cos_f32 v60, v61
    v_sin_f32_e64 v61, -v61
    v_mul_f32 v63, 0x41300000, v12
    v_cos_f32 v62, v63
    v_sin_f32_e64 v63, -v63
    v_mul_f32 v65, 0x41400000, v12
    v_cos_f32 v64, v65
    v_sin_f32_e64 v65, -v65
    v_mul_f32 v67, 0x41500000, v12
    v_cos_f32 v66, v67
    v_sin_f32_e64 v67, -v67
    v_mul_f32 v69, 0x41600000, v12
    v_cos_f32 v68, v69
    v_sin_f32_e64 v69, -v69
    v_mul_f32 v71, 0x41700000, v12
    v_cos_f32 v70, v71
    v_sin_f32_e64 v71, -v71
    s_waitcnt lgkmcnt(0)
    s_barrier
    ds_read_b64 v[116:117], v8 offset:0
    ds_read_b64 v[88:89], v8 offset:64
    ds_read_b64 v[118:119], v8 offset:128
    ds_read_b64 v[104:105], v8 offset:192
    ds_read_b64 v[120:121], v8 offset:256
    ds_read_b64 v[112:113], v8 offset:320
    ds_read_b64 v[100:101], v8 offset:384
    ds_read_b64 v[82:83], v8 offset:448
    ds_read_b64 v[124:125], v8 offset:512
    ds_read_b64 v[90:91], v8 offset:576
    ds_read_b64 v[126:127], v8 offset:640
    ds_read_b64 v[106:107], v8 offset:704
    ds_read_b64 v[102:103], v8 offset:768
    ds_read_b64 v[114:115], v8 offset:832
    ds_read_b64 v[130:131], v8 offset:896
    ds_read_b64 v[86:87], v8 offset:960
    s_waitcnt lgkmcnt(0)
    s_barrier
    v_pk_add_f32 v[132:133], v[116:117], v[124:125] neg_lo:[0,1] neg_hi:[0,1]
    v_pk_add_f32 v[116:117], v[116:117], v[124:125]
    v_pk_add_f32 v[124:125], v[120:121], v[102:103] neg_lo:[0,1] neg_hi:[0,1]
    v_pk_add_f32 v[120:121], v[120:121], v[102:103]
    v_pk_add_f32 v[102:103], v[116:117], v[120:121] neg_lo:[0,1] neg_hi:[0,1]
    v_pk_add_f32 v[116:117], v[116:117], v[120:121]
    v_pk_add_f32 v[120:121], v[132:133], v[124:125] op_sel:[0,1] op_sel_hi:[1,0] neg_hi:[0,1]
    v_pk_add_f32 v[132:133], v[132:133], v[124:125] op_sel:[0,1] op_sel_hi:[1,0] neg_lo:[0,1]
    v_pk_add_f32 v[94:95], v[88:89], v[90:91] neg_lo:[0,1] neg_hi:[0,1]
    v_pk_add_f32 v[88:89], v[88:89], v[90:91]
    v_pk_add_f32 v[90:91], v[112:113], v[114:115] neg_lo:[0,1] neg_hi:[0,1]
    v_pk_add_f32 v[112:113], v[112:113], v[114:115]
    v_pk_add_f32 v[114:115], v[88:89], v[112:113] neg_lo:[0,1] neg_hi:[0,1]
    v_pk_add_f32 v[88:89], v[88:89], v[112:113]
    v_pk_add_f32 v[112:113], v[94:95], v[90:91] op_sel:[0,1] op_sel_hi:[1,0] neg_hi:[0,1]
    v_pk_add_f32 v[94:95], v[94:95], v[90:91] op_sel:[0,1] op_sel_hi:[1,0] neg_lo:[0,1]
    v_pk_mul_f32 v[134:135], v[112:113], s[20:21] op_sel:[0,0] op_sel_hi:[1,0]
    v_pk_fma_f32 v[112:113], v[112:113], s[20:21], v[134:135] op_sel:[1,1,0] op_sel_hi:[0,1,1] neg_lo:[0,1,0]
    v_pk_mul_f32 v[110:111], v[114:115], s[22:23] op_sel:[0,0] op_sel_hi:[1,0]
    v_pk_fma_f32 v[114:115], v[114:115], s[22:23], v[110:111] op_sel:[1,1,0] op_sel_hi:[0,1,1] neg_lo:[0,1,0]
    v_pk_mul_f32 v[84:85], v[94:95], s[24:25] op_sel:[0,0] op_sel_hi:[1,0]
    v_pk_fma_f32 v[94:95], v[94:95], s[24:25], v[84:85] op_sel:[1,1,0] op_sel_hi:[0,1,1] neg_lo:[0,1,0]
    v_pk_add_f32 v[128:129], v[118:119], v[126:127] neg_lo:[0,1] neg_hi:[0,1]
    v_pk_add_f32 v[118:119], v[118:119], v[126:127]
    v_pk_add_f32 v[126:127], v[100:101], v[130:131] neg_lo:[0,1] neg_hi:[0,1]
    v_pk_add_f32 v[100:101], v[100:101], v[130:131]
    v_pk_add_f32 v[130:131], v[118:119], v[100:101] neg_lo:[0,1] neg_hi:[0,1]
    v_pk_add_f32 v[118:119], v[118:119], v[100:101]
    v_pk_add_f32 v[100:101], v[128:129], v[126:127] op_sel:[0,1] op_sel_hi:[1,0] neg_hi:[0,1]
    v_pk_add_f32 v[128:129], v[128:129], v[126:127] op_sel:[0,1] op_sel_hi:[1,0] neg_lo:[0,1]
    v_pk_mul_f32 v[92:93], v[100:101], s[22:23] op_sel:[0,0] op_sel_hi:[1,0]
    v_pk_fma_f32 v[100:101], v[100:101], s[22:23], v[92:93] op_sel:[1,1,0] op_sel_hi:[0,1,1] neg_lo:[0,1,0]
    v_pk_mul_f32 v[136:137], v[128:129], s[22:23] op_sel:[0,0] op_sel_hi:[1,0]
    v_pk_fma_f32 v[128:129], v[128:129], s[22:23], v[136:137] op_sel:[1,1,0] op_sel_hi:[0,1,1] neg_lo:[0,1,0]
    v_pk_add_f32 v[108:109], v[104:105], v[106:107] neg_lo:[0,1] neg_hi:[0,1]
    v_pk_add_f32 v[104:105], v[104:105], v[106:107]
    v_pk_add_f32 v[106:107], v[82:83], v[86:87] neg_lo:[0,1] neg_hi:[0,1]
    v_pk_add_f32 v[82:83], v[82:83], v[86:87]
    v_pk_add_f32 v[86:87], v[104:105], v[82:83] neg_lo:[0,1] neg_hi:[0,1]
    v_pk_add_f32 v[104:105], v[104:105], v[82:83]
    v_pk_add_f32 v[82:83], v[108:109], v[106:107] op_sel:[0,1] op_sel_hi:[1,0] neg_hi:[0,1]
    v_pk_add_f32 v[108:109], v[108:109], v[106:107] op_sel:[0,1] op_sel_hi:[1,0] neg_lo:[0,1]
    v_pk_mul_f32 v[138:139], v[82:83], s[24:25] op_sel:[0,0] op_sel_hi:[1,0]
    v_pk_fma_f32 v[82:83], v[82:83], s[24:25], v[138:139] op_sel:[1,1,0] op_sel_hi:[0,1,1] neg_lo:[0,1,0]
    v_pk_mul_f32 v[122:123], v[86:87], s[22:23] op_sel:[0,0] op_sel_hi:[1,0]
    v_pk_fma_f32 v[86:87], v[86:87], s[22:23], v[122:123] op_sel:[1,1,0] op_sel_hi:[0,1,1] neg_lo:[0,1,0]
    v_pk_mul_f32 v[96:97], v[108:109], s[20:21] op_sel:[0,0] op_sel_hi:[1,0]
    v_pk_fma_f32 v[108:109], v[108:109], s[20:21], v[96:97] op_sel:[1,1,0] op_sel_hi:[0,1,1] neg_lo:[0,1,0]
    v_pk_add_f32 v[80:81], v[116:117], v[118:119] neg_lo:[0,1] neg_hi:[0,1]
    v_pk_add_f32 v[116:117], v[116:117], v[118:119]
    v_pk_add_f32 v[118:119], v[88:89], v[104:105] neg_lo:[0,1] neg_hi:[0,1]
    v_pk_add_f32 v[88:89], v[88:89], v[104:105]
    v_pk_add_f32 v[104:105], v[116:117], v[88:89] neg_lo:[0,1] neg_hi:[0,1]
    v_pk_add_f32 v[116:117], v[116:117], v[88:89]
    v_pk_add_f32 v[88:89], v[80:81], v[118:119] op_sel:[0,1] op_sel_hi:[1,0] neg_hi:[0,1]
    v_pk_add_f32 v[80:81], v[80:81], v[118:119] op_sel:[0,1] op_sel_hi:[1,0] neg_lo:[0,1]
    v_pk_add_f32 v[98:99], v[120:121], v[100:101] neg_lo:[0,1] neg_hi:[0,1]
    v_pk_add_f32 v[120:121], v[120:121], v[100:101]
    v_pk_add_f32 v[100:101], v[112:113], v[82:83] neg_lo:[0,1] neg_hi:[0,1]
    v_pk_add_f32 v[112:113], v[112:113], v[82:83]
    v_pk_add_f32 v[82:83], v[120:121], v[112:113] neg_lo:[0,1] neg_hi:[0,1]
    v_pk_add_f32 v[120:121], v[120:121], v[112:113]
    v_pk_add_f32 v[112:113], v[98:99], v[100:101] op_sel:[0,1] op_sel_hi:[1,0] neg_hi:[0,1]
    v_pk_add_f32 v[98:99], v[98:99], v[100:101] op_sel:[0,1] op_sel_hi:[1,0] neg_lo:[0,1]
    v_pk_add_f32 v[124:125], v[102:103], v[130:131] op_sel:[0,1] op_sel_hi:[1,0] neg_lo:[0,1]
    v_pk_add_f32 v[102:103], v[102:103], v[130:131] op_sel:[0,1] op_sel_hi:[1,0] neg_hi:[0,1]
    v_pk_add_f32 v[130:131], v[114:115], v[86:87] op_sel:[0,1] op_sel_hi:[1,0] neg_lo:[0,1]
    v_pk_add_f32 v[114:115], v[114:115], v[86:87] op_sel:[0,1] op_sel_hi:[1,0] neg_hi:[0,1]
    v_pk_add_f32 v[86:87], v[102:103], v[114:115] neg_lo:[0,1] neg_hi:[0,1]
    v_pk_add_f32 v[102:103], v[102:103], v[114:115]
    v_pk_add_f32 v[114:115], v[124:125], v[130:131] op_sel:[0,1] op_sel_hi:[1,0] neg_hi:[0,1]
    v_pk_add_f32 v[124:125], v[124:125], v[130:131] op_sel:[0,1] op_sel_hi:[1,0] neg_lo:[0,1]
    v_pk_add_f32 v[90:91], v[132:133], v[128:129] op_sel:[0,1] op_sel_hi:[1,0] neg_lo:[0,1]
    v_pk_add_f32 v[132:133], v[132:133], v[128:129] op_sel:[0,1] op_sel_hi:[1,0] neg_hi:[0,1]
    v_pk_add_f32 v[128:129], v[94:95], v[108:109]
    v_pk_add_f32 v[94:95], v[94:95], v[108:109] neg_lo:[0,1] neg_hi:[0,1]
    v_pk_add_f32 v[108:109], v[132:133], v[94:95] neg_lo:[0,1] neg_hi:[0,1]
    v_pk_add_f32 v[132:133], v[132:133], v[94:95]
    v_pk_add_f32 v[94:95], v[90:91], v[128:129] op_sel:[0,1] op_sel_hi:[1,0] neg_hi:[0,1]
    v_pk_add_f32 v[90:91], v[90:91], v[128:129] op_sel:[0,1] op_sel_hi:[1,0] neg_lo:[0,1]
    v_pk_mul_f32 v[134:135], v[116:117], v[72:73] op_sel:[0,0] op_sel_hi:[1,0]
    v_pk_fma_f32 v[116:117], v[116:117], v[72:73], v[134:135] op_sel:[1,1,0] op_sel_hi:[0,1,1] neg_lo:[0,1,0]
    ds_write_b64 v10, v[116:117] offset:0
    v_pk_mul_f32 v[110:111], v[120:121], v[42:43] op_sel:[0,0] op_sel_hi:[1,0]
    v_pk_fma_f32 v[120:121], v[120:121], v[42:43], v[110:111] op_sel:[1,1,0] op_sel_hi:[0,1,1] neg_lo:[0,1,0]
    ds_write_b64 v10, v[120:121] offset:1280
    v_pk_mul_f32 v[84:85], v[102:103], v[44:45] op_sel:[0,0] op_sel_hi:[1,0]
    v_pk_fma_f32 v[102:103], v[102:103], v[44:45], v[84:85] op_sel:[1,1,0] op_sel_hi:[0,1,1] neg_lo:[0,1,0]
    ds_write_b64 v10, v[102:103] offset:2560
    v_pk_mul_f32 v[126:127], v[132:133], v[46:47] op_sel:[0,0] op_sel_hi:[1,0]
    v_pk_fma_f32 v[132:133], v[132:133], v[46:47], v[126:127] op_sel:[1,1,0] op_sel_hi:[0,1,1] neg_lo:[0,1,0]
    ds_write_b64 v10, v[132:133] offset:3840
    v_pk_mul_f32 v[92:93], v[88:89], v[48:49] op_sel:[0,0] op_sel_hi:[1,0]
    v_pk_fma_f32 v[88:89], v[88:89], v[48:49], v[92:93] op_sel:[1,1,0] op_sel_hi:[0,1,1] neg_lo:[0,1,0]
    ds_write_b64 v10, v[88:89] offset:5120
    v_pk_mul_f32 v[136:137], v[112:113], v[50:51] op_sel:[0,0] op_sel_hi:[1,0]
    v_pk_fma_f32 v[112:113], v[112:113], v[50:51], v[136:137] op_sel:[1,1,0] op_sel_hi:[0,1,1] neg_lo:[0,1,0]
    ds_write_b64 v10, v[112:113] offset:6400
    v_pk_mul_f32 v[106:107], v[114:115], v[52:53] op_sel:[0,0] op_sel_hi:[1,0]
    v_pk_fma_f32 v[114:115], v[114:115], v[52:53], v[106:107] op_sel:[1,1,0] op_sel_hi:[0,1,1] neg_lo:[0,1,0]
    ds_write_b64 v10, v[114:115] offset:7680
    v_pk_mul_f32 v[138:139], v[94:95], v[54:55] op_sel:[0,0] op_sel_hi:[1,0]
    v_pk_fma_f32 v[94:95], v[94:95], v[54:55], v[138:139] op_sel:[1,1,0] op_sel_hi:[0,1,1] neg_lo:[0,1,0]
    ds_write_b64 v10, v[94:95] offset:8960
    v_pk_mul_f32 v[122:123], v[104:105], v[56:57] op_sel:[0,0] op_sel_hi:[1,0]
    v_pk_fma_f32 v[104:105], v[104:105], v[56:57], v[122:123] op_sel:[1,1,0] op_sel_hi:[0,1,1] neg_lo:[0,1,0]
    ds_write_b64 v10, v[104:105] offset:10240
    v_pk_mul_f32 v[96:97], v[82:83], v[58:59] op_sel:[0,0] op_sel_hi:[1,0]
    v_pk_fma_f32 v[82:83], v[82:83], v[58:59], v[96:97] op_sel:[1,1,0] op_sel_hi:[0,1,1] neg_lo:[0,1,0]
    ds_write_b64 v10, v[82:83] offset:11520
    v_pk_mul_f32 v[118:119], v[86:87], v[60:61] op_sel:[0,0] op_sel_hi:[1,0]
    v_pk_fma_f32 v[86:87], v[86:87], v[60:61], v[118:119] op_sel:[1,1,0] op_sel_hi:[0,1,1] neg_lo:[0,1,0]
    ds_write_b64 v10, v[86:87] offset:12800
    v_pk_mul_f32 v[100:101], v[108:109], v[62:63] op_sel:[0,0] op_sel_hi:[1,0]
    v_pk_fma_f32 v[108:109], v[108:109], v[62:63], v[100:101] op_sel:[1,1,0] op_sel_hi:[0,1,1] neg_lo:[0,1,0]
    ds_write_b64 v10, v[108:109] offset:14080
    v_pk_mul_f32 v[130:131], v[80:81], v[64:65] op_sel:[0,0] op_sel_hi:[1,0]
    v_pk_fma_f32 v[80:81], v[80:81], v[64:65], v[130:131] op_sel:[1,1,0] op_sel_hi:[0,1,1] neg_lo:[0,1,0]
    ds_write_b64 v10, v[80:81] offset:15360
    v_pk_mul_f32 v[128:129], v[98:99], v[66:67] op_sel:[0,0] op_sel_hi:[1,0]
    v_pk_fma_f32 v[98:99], v[98:99], v[66:67], v[128:129] op_sel:[1,1,0] op_sel_hi:[0,1,1] neg_lo:[0,1,0]
    ds_write_b64 v10, v[98:99] offset:16640
    v_pk_mul_f32 v[134:135], v[124:125], v[68:69] op_sel:[0,0] op_sel_hi:[1,0]
    v_pk_fma_f32 v[124:125], v[124:125], v[68:69], v[134:135] op_sel:[1,1,0] op_sel_hi:[0,1,1] neg_lo:[0,1,0]
    ds_write_b64 v10, v[124:125] offset:17920
    v_pk_mul_f32 v[116:117], v[90:91], v[70:71] op_sel:[0,0] op_sel_hi:[1,0]
    v_pk_fma_f32 v[90:91], v[90:91], v[70:71], v[116:117] op_sel:[1,1,0] op_sel_hi:[0,1,1] neg_lo:[0,1,0]
    ds_write_b64 v10, v[90:91] offset:19200
    s_waitcnt lgkmcnt(0)
    s_barrier
    s_mov_b32 s42, 0x34800000
    s_mov_b32 s43, 0x34800000
    s_mov_b32 s48, s46
    s_cmp_eq_u32 s46, 0
    s_cbranch_scc1 L_k2_kernel_r0_nopf
    s_mov_b32 s52, 35651584
    s_mov_b32 s53, 35655680
    buffer_load_dword v80, v14, s[12:15], s52 offen offset:0
    buffer_load_dword v81, v14, s[12:15], s52 offen offset:1024
    buffer_load_dword v82, v14, s[12:15], s52 offen offset:2048
    buffer_load_dword v83, v14, s[12:15], s52 offen offset:3072
    buffer_load_dword v84, v14, s[12:15], s53 offen offset:0
    buffer_load_dword v85, v14, s[12:15], s53 offen offset:1024
    buffer_load_dword v86, v14, s[12:15], s53 offen offset:2048
    buffer_load_dword v87, v14, s[12:15], s53 offen offset:3072
    buffer_load_dword v88, v16, s[12:15], s52 offen
    buffer_load_dword v89, v15, s[12:15], s53 offen offset:2048
    buffer_load_dword v90, v15, s[12:15], s53 offen offset:1024
    buffer_load_dword v91, v15, s[12:15], s53 offen offset:0
    buffer_load_dword v92, v15, s[12:15], s52 offen offset:3072
    buffer_load_dword v93, v15, s[12:15], s52 offen offset:2048
    buffer_load_dword v94, v15, s[12:15], s52 offen offset:1024
    buffer_load_dword v95, v15, s[12:15], s52 offen offset:0
L_k2_kernel_r0_nopf:
L_k2_kernel_r0_st3:
    ds_read_b128 v[100:103], v11 offset:0
    ds_read_b128 v[104:107], v11 offset:16
    ds_read_b128 v[108:111], v11 offset:32
    ds_read_b128 v[112:115], v11 offset:48
    ds_read_b128 v[116:119], v13 offset:0
    ds_read_b128 v[120:123], v13 offset:16
    ds_read_b128 v[124:127], v13 offset:32
    ds_read_b128 v[128:131], v13 offset:48
    s_waitcnt lgkmcnt(4)
    v_sub_f32 v132, v100, v108
    v_sub_f32 v133, v101, v109
    v_add_f32 v100, v100, v108
    v_add_f32 v101, v101, v109
    v_sub_f32 v136, v102, v110
    v_sub_f32 v137, v103, v111
    v_add_f32 v102, v102, v110
    v_add_f32 v103, v103, v111
    v_mul_f32 v138, s22, v136
    v_mul_f32 v139, s23, v136
    v_fma_f32 v136, -v137, s23, v138
    v_fma_f32 v137, v137, s22, v139
    v_sub_f32 v96, v104, v112
    v_sub_f32 v97, v105, v113
    v_add_f32 v104, v104, v112
    v_add_f32 v105, v105, v113
    v_sub_f32 v98, v106, v114
    v_sub_f32 v99, v107, v115
    v_add_f32 v106, v106, v114
    v_add_f32 v107, v107, v115
    v_mul_f32 v134, s22, v98
    v_mul_f32 v135, s23, v98
    v_fma_f32 v98, -v99, s23, v134
    v_fma_f32 v99, v99, s22, v135
    v_sub_f32 v108, v100, v104
    v_sub_f32 v109, v101, v105
    v_add_f32 v100, v100, v104
    v_add_f32 v101, v101, v105
    v_sub_f32 v104, v102, v106
    v_sub_f32 v105, v103, v107
    v_add_f32 v102, v102, v106
    v_add_f32 v103, v103, v107
    v_sub_f32 v106, v100, v102
    v_sub_f32 v107, v101, v103
    v_add_f32 v100, v100, v102
    v_add_f32 v101, v101, v103
    v_add_f32 v102, v108, v105
    v_sub_f32 v103, v109, v104
    v_sub_f32 v108, v108, v105
    v_add_f32 v109, v109, v104
    v_sub_f32 v110, v132, v97
    v_add_f32 v111, v133, v96
    v_add_f32 v132, v132, v97
    v_sub_f32 v133, v133, v96
    v_sub_f32 v96, v136, v99
    v_add_f32 v97, v137, v98
    v_add_f32 v136, v136, v99
    v_sub_f32 v137, v137, v98
    v_sub_f32 v98, v132, v136
    v_sub_f32 v99, v133, v137
    v_add_f32 v132, v132, v136
    v_add_f32 v133, v133, v137
    v_add_f32 v136, v110, v97
    v_sub_f32 v137, v111, v96
    v_sub_f32 v110, v110, v97
    v_add_f32 v111, v111, v96
    s_waitcnt lgkmcnt(0)
    v_sub_f32 v138, v116, v124
    v_sub_f32 v139, v117, v125
    v_add_f32 v116, v116, v124
    v_add_f32 v117, v117, v125
    v_sub_f32 v112, v118, v126
    v_sub_f32 v113, v119, v127
    v_add_f32 v118, v118, v126
    v_add_f32 v119, v119, v127
    v_mul_f32 v114, s22, v112
    v_mul_f32 v115, s23, v112
    v_fma_f32 v112, -v113, s23, v114
    v_fma_f32 v113, v113, s22, v115
    v_sub_f32 v134, v120, v128
    v_sub_f32 v135, v121, v129
    v_add_f32 v120, v120, v128
    v_add_f32 v121, v121, v129
    v_sub_f32 v104, v122, v130
    v_sub_f32 v105, v123, v131
    v_add_f32 v122, v122, v130
    v_add_f32 v123, v123, v131
    v_mul_f32 v96, s22, v104
    v_mul_f32 v97, s23, v104
    v_fma_f32 v104, -v105, s23, v96
    v_fma_f32 v105, v105, s22, v97
    v_sub_f32 v124, v116, v120
    v_sub_f32 v125, v117, v121
    v_add_f32 v116, v116, v120
    v_add_f32 v117, v117, v121
    v_sub_f32 v120, v118, v122
    v_sub_f32 v121, v119, v123
    v_add_f32 v118, v118, v122
    v_add_f32 v119, v119, v123
    v_sub_f32 v122, v116, v118
    v_sub_f32 v123, v117, v119
    v_add_f32 v116, v116, v118
    v_add_f32 v117, v117, v119
    v_add_f32 v118, v124, v121
    v_sub_f32 v119, v125, v120
    v_sub_f32 v124, v124, v121
    v_add_f32 v125, v125, v120
    v_sub_f32 v126, v138, v135
    v_add_f32 v127, v139, v134
    v_add_f32 v138, v138, v135
    v_sub_f32 v139, v139, v134
    v_sub_f32 v134, v112, v105
    v_add_f32 v135, v113, v104
    v_add_f32 v112, v112, v105
    v_sub_f32 v113, v113, v104
    v_sub_f32 v104, v138, v112
    v_sub_f32 v105, v139, v113
    v_add_f32 v138, v138, v112
    v_add_f32 v139, v139, v113
    v_add_f32 v112, v126, v135
    v_sub_f32 v113, v127, v134
    v_sub_f32 v126, v126, v135
    v_add_f32 v127, v127, v134
    s_barrier
    s_cmp_eq_u32 s46, 0
    s_cbranch_scc1 L_k2_kernel_r0_norot
    v_cmp_eq_u32 vcc, 0, v0
    s_and_saveexec_b64 s[50:51], vcc
    v_mov_b32 v74, v116
    v_mov_b32 v75, v117
    v_mov_b32 v116, v138
    v_mov_b32 v117, v139
    v_mov_b32 v138, v118
    v_mov_b32 v139, v119
    v_mov_b32 v118, v112
    v_mov_b32 v119, v113
    v_mov_b32 v112, v122
    v_mov_b32 v113, v123
    v_mov_b32 v122, v104
    v_mov_b32 v123, v105
    v_mov_b32 v104, v124
    v_mov_b32 v105, v125
    v_mov_b32 v124, v126
    v_mov_b32 v125, v127
    v_mov_b32 v126, v74
    v_mov_b32 v127, v75
    s_mov_b64 exec, s[50:51]
L_k2_kernel_r0_norot:
    s_waitcnt vmcnt(0)
    v_lshlrev_b32 v74, 16, v140
    v_and_b32 v75, 0xffff0000, v140
    v_lshlrev_b32 v76, 16, v148
    v_and_b32 v77, 0xffff0000, v148
    s_cmp_eq_u32 s48, 0
    s_cbranch_scc1 L_k2_kernel_r0_s0
    v_lshlrev_b32 v78, 16, v20
    v_and_b32 v79, 0xffff0000, v20
    v_add_f32 v74, v74, v78
    v_sub_f32 v75, v75, v79
    v_mul_f32 v74, 0.5, v74
    v_mul_f32 v75, 0.5, v75
    v_lshlrev_b32 v78, 16, v28
    v_and_b32 v79, 0xffff0000, v28
    v_add_f32 v76, v76, v78
    v_sub_f32 v77, v77, v79
    v_mul_f32 v76, 0.5, v76
    v_mul_f32 v77, 0.5, v77
L_k2_kernel_r0_s0:
    v_mul_f32 v74, s42, v74
    v_mul_f32 v75, s42, v75
    v_mul_f32 v76, s42, v76
    v_mul_f32 v77, s42, v77
    v_add_f32 v114, v100, v126
    v_sub_f32 v115, v101, v127
    v_sub_f32 v128, v100, v126
    v_add_f32 v129, v101, v127
    v_mul_f32 v130, s44, v128
    v_mul_f32 v131, s45, v128
    v_fma_f32 v128, -v129, s45, v130
    v_fma_f32 v129, v129, s44, v131
    v_add_f32 v100, v114, v129
    v_sub_f32 v101, v115, v128
    v_sub_f32 v126, v114, v129
    v_add_f32 v127, v115, v128
    v_mul_f32 v96, v74, v100
    v_mul_f32 v97, v75, v100
    v_fma_f32 v100, -v101, v75, v96
    v_fma_f32 v101, v101, v74, v97
    v_mul_f32 v120, v76, v126
    v_mul_f32 v121, v77, v126
    v_fma_f32 v126, v127, v77, v120
    v_fma_f32 v127, v127, v76, -v121
    v_add_f32 v114, v100, v126
    v_add_f32 v115, v101, v127
    v_sub_f32 v128, v100, v126
    v_sub_f32 v129, v101, v127
    v_mul_f32 v134, s44, v128
    v_mul_f32 v135, s45, v128
    v_fma_f32 v128, v129, s45, v134
    v_fma_f32 v129, v129, s44, -v135
    v_sub_f32 v100, v114, v129
    v_add_f32 v101, v115, v128
    v_add_f32 v126, v114, v129
    v_sub_f32 v127, v128, v115
    v_lshlrev_b32 v74, 16, v141
    v_and_b32 v75, 0xffff0000, v141
    v_lshlrev_b32 v76, 16, v149
    v_and_b32 v77, 0xffff0000, v149
    s_cmp_eq_u32 s48, 0
    s_cbranch_scc1 L_k2_kernel_r0_s1
    v_lshlrev_b32 v78, 16, v21
    v_and_b32 v79, 0xffff0000, v21
    v_add_f32 v74, v74, v78
    v_sub_f32 v75, v75, v79
    v_mul_f32 v74, 0.5, v74
    v_mul_f32 v75, 0.5, v75
    v_lshlrev_b32 v78, 16, v29
    v_and_b32 v79, 0xffff0000, v29
    v_add_f32 v76, v76, v78
    v_sub_f32 v77, v77, v79
    v_mul_f32 v76, 0.5, v76
    v_mul_f32 v77, 0.5, v77
L_k2_kernel_r0_s1:
    v_mul_f32 v74, s42, v74
    v_mul_f32 v75, s42, v75
    v_mul_f32 v76, s42, v76
    v_mul_f32 v77, s42, v77
    v_add_f32 v130, v132, v124
    v_sub_f32 v131, v133, v125
    v_sub_f32 v96, v132, v124
    v_add_f32 v97, v133, v125
    v_mul_f32 v120, s44, v96
    v_mul_f32 v121, s45, v96
    v_fma_f32 v96, -v97, s45, v120
    v_fma_f32 v97, v97, s44, v121
    v_add_f32 v132, v130, v97
    v_sub_f32 v133, v131, v96
    v_sub_f32 v124, v130, v97
    v_add_f32 v125, v131, v96
    v_mul_f32 v134, v74, v132
    v_mul_f32 v135, v75, v132
    v_fma_f32 v132, -v133, v75, v134
    v_fma_f32 v133, v133, v74, v135
    v_mul_f32 v114, v76, v124
    v_mul_f32 v115, v77, v124
    v_fma_f32 v124, v125, v77, v114
    v_fma_f32 v125, v125, v76, -v115
    v_add_f32 v130, v132, v124
    v_add_f32 v131, v133, v125
    v_sub_f32 v96, v132, v124
    v_sub_f32 v97, v133, v125
    v_mul_f32 v128, s44, v96
    v_mul_f32 v129, s45, v96
    v_fma_f32 v96, v97, s45, v128
    v_fma_f32 v97, v97, s44, -v129
    v_sub_f32 v132, v130, v97
    v_add_f32 v133, v131, v96
    v_add_f32 v124, v130, v97
    v_sub_f32 v125, v96, v131
    v_lshlrev_b32 v74, 16, v142
    v_and_b32 v75, 0xffff0000, v142
    v_lshlrev_b32 v76, 16, v150
    v_and_b32 v77, 0xffff0000, v150
    s_cmp_eq_u32 s48, 0
    s_cbranch_scc1 L_k2_kernel_r0_s2
    v_lshlrev_b32 v78, 16, v22
    v_and_b32 v79, 0xffff0000, v22
    v_add_f32 v74, v74, v78
    v_sub_f32 v75, v75, v79
    v_mul_f32 v74, 0.5, v74
    v_mul_f32 v75, 0.5, v75
    v_lshlrev_b32 v78, 16, v30
    v_and_b32 v79, 0xffff0000, v30
    v_add_f32 v76, v76, v78
    v_sub_f32 v77, v77, v79
    v_mul_f32 v76, 0.5, v76
    v_mul_f32 v77, 0.5, v77
L_k2_kernel_r0_s2:
    v_mul_f32 v74, s42, v74
    v_mul_f32 v75, s42, v75
    v_mul_f32 v76, s42, v76
    v_mul_f32 v77, s42, v77
    v_add_f32 v120, v102, v104
    v_sub_f32 v121, v103, v105
    v_sub_f32 v134, v102, v104
    v_add_f32 v135, v103, v105
    v_mul_f32 v114, s44, v134
    v_mul_f32 v115, s45, v134
    v_fma_f32 v134, -v135, s45, v114
    v_fma_f32 v135, v135, s44, v115
    v_add_f32 v102, v120, v135
    v_sub_f32 v103, v121, v134
    v_sub_f32 v104, v120, v135
    v_add_f32 v105, v121, v134
    v_mul_f32 v128, v74, v102
    v_mul_f32 v129, v75, v102
    v_fma_f32 v102, -v103, v75, v128
    v_fma_f32 v103, v103, v74, v129
    v_mul_f32 v130, v76, v104
    v_mul_f32 v131, v77, v104
    v_fma_f32 v104, v105, v77, v130
    v_fma_f32 v105, v105, v76, -v131
    v_add_f32 v120, v102, v104
    v_add_f32 v121, v103, v105
    v_sub_f32 v134, v102, v104
    v_sub_f32 v135, v103, v105
    v_mul_f32 v96, s44, v134
    v_mul_f32 v97, s45, v134
    v_fma_f32 v134, v135, s45, v96
    v_fma_f32 v135, v135, s44, -v97
    v_sub_f32 v102, v120, v135
    v_add_f32 v103, v121, v134
    v_add_f32 v104, v120, v135
    v_sub_f32 v105, v134, v121
    v_lshlrev_b32 v74, 16, v143
    v_and_b32 v75, 0xffff0000, v143
    v_lshlrev_b32 v76, 16, v151
    v_and_b32 v77, 0xffff0000, v151
    s_cmp_eq_u32 s48, 0
    s_cbranch_scc1 L_k2_kernel_r0_s3
    v_lshlrev_b32 v78, 16, v23
    v_and_b32 v79, 0xffff0000, v23
    v_add_f32 v74, v74, v78
    v_sub_f32 v75, v75, v79
    v_mul_f32 v74, 0.5, v74
    v_mul_f32 v75, 0.5, v75
    v_lshlrev_b32 v78, 16, v31
    v_and_b32 v79, 0xffff0000, v31
    v_add_f32 v76, v76, v78
    v_sub_f32 v77, v77, v79
    v_mul_f32 v76, 0.5, v76
    v_mul_f32 v77, 0.5, v77
L_k2_kernel_r0_s3:
    v_mul_f32 v74, s42, v74
    v_mul_f32 v75, s42, v75
    v_mul_f32 v76, s42, v76
    v_mul_f32 v77, s42, v77
    v_add_f32 v114, v136, v122
    v_sub_f32 v115, v137, v123
    v_sub_f32 v128, v136, v122
    v_add_f32 v129, v137, v123
    v_mul_f32 v130, s44, v128
    v_mul_f32 v131, s45, v128
    v_fma_f32 v128, -v129, s45, v130
    v_fma_f32 v129, v129, s44, v131
    v_add_f32 v136, v114, v129
    v_sub_f32 v137, v115, v128
    v_sub_f32 v122, v114, v129
    v_add_f32 v123, v115, v128
    v_mul_f32 v96, v74, v136
    v_mul_f32 v97, v75, v136
    v_fma_f32 v136, -v137, v75, v96
    v_fma_f32 v137, v137, v74, v97
    v_mul_f32 v120, v76, v122
    v_mul_f32 v121, v77, v122
    v_fma_f32 v122, v123, v77, v120
    v_fma_f32 v123, v123, v76, -v121
    v_add_f32 v114, v136, v122
    v_add_f32 v115, v137, v123
    v_sub_f32 v128, v136, v122
    v_sub_f32 v129, v137, v123
    v_mul_f32 v134, s44, v128
    v_mul_f32 v135, s45, v128
    v_fma_f32 v128, v129, s45, v134
    v_fma_f32 v129, v129, s44, -v135
    v_sub_f32 v136, v114, v129
    v_add_f32 v137, v115, v128
    v_add_f32 v122, v114, v129
    v_sub_f32 v123, v128, v115
    v_lshlrev_b32 v74, 16, v144
    v_and_b32 v75, 0xffff0000, v144
    v_lshlrev_b32 v76, 16, v152
    v_and_b32 v77, 0xffff0000, v152
    s_cmp_eq_u32 s48, 0
    s_cbranch_scc1 L_k2_kernel_r0_s4
    v_lshlrev_b32 v78, 16, v24
    v_and_b32 v79, 0xffff0000, v24
    v_add_f32 v74, v74, v78
    v_sub_f32 v75, v75, v79
    v_mul_f32 v74, 0.5, v74
    v_mul_f32 v75, 0.5, v75
    v_lshlrev_b32 v78, 16, v32
    v_and_b32 v79, 0xffff0000, v32
    v_add_f32 v76, v76, v78
    v_sub_f32 v77, v77, v79
    v_mul_f32 v76, 0.5, v76
    v_mul_f32 v77, 0.5, v77
L_k2_kernel_r0_s4:
    v_mul_f32 v74, s42, v74
    v_mul_f32 v75, s42, v75
    v_mul_f32 v76, s42, v76
    v_mul_f32 v77, s42, v77
    v_add_f32 v130, v106, v112
    v_sub_f32 v131, v107, v113
    v_sub_f32 v96, v106, v112
    v_add_f32 v97, v107, v113
    v_mul_f32 v120, s44, v96
    v_mul_f32 v121, s45, v96
    v_fma_f32 v96, -v97, s45, v120
    v_fma_f32 v97, v97, s44, v121
    v_add_f32 v106, v130, v97
    v_sub_f32 v107, v131, v96
    v_sub_f32 v112, v130, v97
    v_add_f32 v113, v131, v96
    v_mul_f32 v134, v74, v106
    v_mul_f32 v135, v75, v106
    v_fma_f32 v106, -v107, v75, v134
    v_fma_f32 v107, v107, v74, v135
    v_mul_f32 v114, v76, v112
    v_mul_f32 v115, v77, v112
    v_fma_f32 v112, v113, v77, v114
    v_fma_f32 v113, v113, v76, -v115
    v_add_f32 v130, v106, v112
    v_add_f32 v131, v107, v113
    v_sub_f32 v96, v106, v112
    v_sub_f32 v97, v107, v113
    v_mul_f32 v128, s44, v96
    v_mul_f32 v129, s45, v96
    v_fma_f32 v96, v97, s45, v128
    v_fma_f32 v97, v97, s44, -v129
    v_sub_f32 v106, v130, v97
    v_add_f32 v107, v131, v96
    v_add_f32 v112, v130, v97
    v_sub_f32 v113, v96, v131
    v_lshlrev_b32 v74, 16, v145
    v_and_b32 v75, 0xffff0000, v145
    v_lshlrev_b32 v76, 16, v153
    v_and_b32 v77, 0xffff0000, v153
    s_cmp_eq_u32 s48, 0
    s_cbranch_scc1 L_k2_kernel_r0_s5
    v_lshlrev_b32 v78, 16, v25
    v_and_b32 v79, 0xffff0000, v25
    v_add_f32 v74, v74, v78
    v_sub_f32 v75, v75, v79
    v_mul_f32 v74, 0.5, v74
    v_mul_f32 v75, 0.5, v75
    v_lshlrev_b32 v78, 16, v33
    v_and_b32 v79, 0xffff0000, v33
    v_add_f32 v76, v76, v78
    v_sub_f32 v77, v77, v79
    v_mul_f32 v76, 0.5, v76
    v_mul_f32 v77, 0.5, v77
L_k2_kernel_r0_s5:
    v_mul_f32 v74, s42, v74
    v_mul_f32 v75, s42, v75
    v_mul_f32 v76, s42, v76
    v_mul_f32 v77, s42, v77
    v_add_f32 v120, v98, v118
    v_sub_f32 v121, v99, v119
    v_sub_f32 v134, v98, v118
    v_add_f32 v135, v99, v119
    v_mul_f32 v114, s44, v134
    v_mul_f32 v115, s45, v134
    v_fma_f32 v134, -v135, s45, v114
    v_fma_f32 v135, v135, s44, v115
    v_add_f32 v98, v120, v135
    v_sub_f32 v99, v121, v134
    v_sub_f32 v118, v120, v135
    v_add_f32 v119, v121, v134
    v_mul_f32 v128, v74, v98
    v_mul_f32 v129, v75, v98
    v_fma_f32 v98, -v99, v75, v128
    v_fma_f32 v99, v99, v74, v129
    v_mul_f32 v130, v76, v118
    v_mul_f32 v131, v77, v118
    v_fma_f32 v118, v119, v77, v130
    v_fma_f32 v119, v119, v76, -v131
    v_add_f32 v120, v98, v118
    v_add_f32 v121, v99, v119
    v_sub_f32 v134, v98, v118
    v_sub_f32 v135, v99, v119
    v_mul_f32 v96, s44, v134
    v_mul_f32 v97, s45, v134
    v_fma_f32 v134, v135, s45, v96
    v_fma_f32 v135, v135, s44, -v97
    v_sub_f32 v98, v120, v135
    v_add_f32 v99, v121, v134
    v_add_f32 v118, v120, v135
    v_sub_f32 v119, v134, v121
    v_lshlrev_b32 v74, 16, v146
    v_and_b32 v75, 0xffff0000, v146
    v_lshlrev_b32 v76, 16, v154
    v_and_b32 v77, 0xffff0000, v154
    s_cmp_eq_u32 s48, 0
    s_cbranch_scc1 L_k2_kernel_r0_s6
    v_lshlrev_b32 v78, 16, v26
    v_and_b32 v79, 0xffff0000, v26
    v_add_f32 v74, v74, v78
    v_sub_f32 v75, v75, v79
    v_mul_f32 v74, 0.5, v74
    v_mul_f32 v75, 0.5, v75
    v_lshlrev_b32 v78, 16, v34
    v_and_b32 v79, 0xffff0000, v34
    v_add_f32 v76, v76, v78
    v_sub_f32 v77, v77, v79
    v_mul_f32 v76, 0.5, v76
    v_mul_f32 v77, 0.5, v77
L_k2_kernel_r0_s6:
    v_mul_f32 v74, s42, v74
    v_mul_f32 v75, s42, v75
    v_mul_f32 v76, s42, v76
    v_mul_f32 v77, s42, v77
    v_add_f32 v114, v108, v138
    v_sub_f32 v115, v109, v139
    v_sub_f32 v128, v108, v138
    v_add_f32 v129, v109, v139
    v_mul_f32 v130, s44, v128
    v_mul_f32 v131, s45, v128
    v_fma_f32 v128, -v129, s45, v130
    v_fma_f32 v129, v129, s44, v131
    v_add_f32 v108, v114, v129
    v_sub_f32 v109, v115, v128
    v_sub_f32 v138, v114, v129
    v_add_f32 v139, v115, v128
    v_mul_f32 v96, v74, v108
    v_mul_f32 v97, v75, v108
    v_fma_f32 v108, -v109, v75, v96
    v_fma_f32 v109, v109, v74, v97
    v_mul_f32 v120, v76, v138
    v_mul_f32 v121, v77, v138
    v_fma_f32 v138, v139, v77, v120
    v_fma_f32 v139, v139, v76, -v121
    v_add_f32 v114, v108, v138
    v_add_f32 v115, v109, v139
    v_sub_f32 v128, v108, v138
    v_sub_f32 v129, v109, v139
    v_mul_f32 v134, s44, v128
    v_mul_f32 v135, s45, v128
    v_fma_f32 v128, v129, s45, v134
    v_fma_f32 v129, v129, s44, -v135
    v_sub_f32 v108, v114, v129
    v_add_f32 v109, v115, v128
    v_add_f32 v138, v114, v129
    v_sub_f32 v139, v128, v115
    v_lshlrev_b32 v74, 16, v147
    v_and_b32 v75, 0xffff0000, v147
    v_lshlrev_b32 v76, 16, v155
    v_and_b32 v77, 0xffff0000, v155
    s_cmp_eq_u32 s48, 0
    s_cbranch_scc1 L_k2_kernel_r0_s7
    v_lshlrev_b32 v78, 16, v27
    v_and_b32 v79, 0xffff0000, v27
    v_add_f32 v74, v74, v78
    v_sub_f32 v75, v75, v79
    v_mul_f32 v74, 0.5, v74
    v_mul_f32 v75, 0.5, v75
    v_lshlrev_b32 v78, 16, v35
    v_and_b32 v79, 0xffff0000, v35
    v_add_f32 v76, v76, v78
    v_sub_f32 v77, v77, v79
    v_mul_f32 v76, 0.5, v76
    v_mul_f32 v77, 0.5, v77
L_k2_kernel_r0_s7:
    v_mul_f32 v74, s42, v74
    v_mul_f32 v75, s42, v75
    v_mul_f32 v76, s42, v76
    v_mul_f32 v77, s42, v77
    v_add_f32 v130, v110, v116
    v_sub_f32 v131, v111, v117
    v_sub_f32 v96, v110, v116
    v_add_f32 v97, v111, v117
    v_mul_f32 v120, s44, v96
    v_mul_f32 v121, s45, v96
    v_fma_f32 v96, -v97, s45, v120
    v_fma_f32 v97, v97, s44, v121
    v_add_f32 v110, v130, v97
    v_sub_f32 v111, v131, v96
    v_sub_f32 v116, v130, v97
    v_add_f32 v117, v131, v96
    v_mul_f32 v134, v74, v110
    v_mul_f32 v135, v75, v110
    v_fma_f32 v110, -v111, v75, v134
    v_fma_f32 v111, v111, v74, v135
    v_mul_f32 v114, v76, v116
    v_mul_f32 v115, v77, v116
    v_fma_f32 v116, v117, v77, v114
    v_fma_f32 v117, v117, v76, -v115
    v_add_f32 v130, v110, v116
    v_add_f32 v131, v111, v117
    v_sub_f32 v96, v110, v116
    v_sub_f32 v97, v111, v117
    v_mul_f32 v128, s44, v96
    v_mul_f32 v129, s45, v96
    v_fma_f32 v96, v97, s45, v128
    v_fma_f32 v97, v97, s44, -v129
    v_sub_f32 v110, v130, v97
    v_add_f32 v111, v131, v96
    v_add_f32 v116, v130, v97
    v_sub_f32 v117, v96, v131
    v_sub_f32 v120, v100, v106
    v_sub_f32 v121, v101, v107
    v_add_f32 v100, v100, v106
    v_add_f32 v101, v101, v107
    v_sub_f32 v134, v132, v98
    v_sub_f32 v135, v133, v99
    v_add_f32 v132, v132, v98
    v_add_f32 v133, v133, v99
    v_mul_f32 v114, s22, v134
    v_mul_f32 v115, s23, v134
    v_fma_f32 v134, v135, s23, v114
    v_fma_f32 v135, v135, s22, -v115
    v_sub_f32 v128, v102, v108
    v_sub_f32 v129, v103, v109
    v_add_f32 v102, v102, v108
    v_add_f32 v103, v103, v109
    v_sub_f32 v130, v136, v110
    v_sub_f32 v131, v137, v111
    v_add_f32 v136, v136, v110
    v_add_f32 v137, v137, v111
    v_mul_f32 v96, s22, v130
    v_mul_f32 v97, s23, v130
    v_fma_f32 v130, v131, s23, v96
    v_fma_f32 v131, v131, s22, -v97
    v_sub_f32 v106, v100, v102
    v_sub_f32 v107, v101, v103
    v_add_f32 v100, v100, v102
    v_add_f32 v101, v101, v103
    v_sub_f32 v102, v132, v136
    v_sub_f32 v103, v133, v137
    v_add_f32 v132, v132, v136
    v_add_f32 v133, v133, v137
    v_sub_f32 v136, v100, v132
    v_sub_f32 v137, v101, v133
    v_add_f32 v100, v100, v132
    v_add_f32 v101, v101, v133
    v_sub_f32 v132, v106, v103
    v_add_f32 v133, v107, v102
    v_add_f32 v106, v106, v103
    v_sub_f32 v107, v107, v102
    v_add_f32 v98, v120, v129
    v_sub_f32 v99, v121, v128
    v_sub_f32 v120, v120, v129
    v_add_f32 v121, v121, v128
    v_add_f32 v128, v134, v131
    v_sub_f32 v129, v135, v130
    v_sub_f32 v134, v134, v131
    v_add_f32 v135, v135, v130
    v_sub_f32 v130, v120, v134
    v_sub_f32 v131, v121, v135
    v_add_f32 v120, v120, v134
    v_add_f32 v121, v121, v135
    v_sub_f32 v134, v98, v129
    v_add_f32 v135, v99, v128
    v_add_f32 v98, v98, v129
    v_sub_f32 v99, v99, v128
    ds_write_b64 v11, v[100:101] offset:0
    ds_write_b64 v11, v[120:121] offset:8
    ds_write_b64 v11, v[132:133] offset:16
    ds_write_b64 v11, v[134:135] offset:24
    ds_write_b64 v11, v[136:137] offset:32
    ds_write_b64 v11, v[130:131] offset:40
    ds_write_b64 v11, v[106:107] offset:48
    ds_write_b64 v11, v[98:99] offset:56
    s_cmp_eq_u32 s46, 1
    s_cbranch_scc1 L_k2_kernel_r0_mnext
    v_sub_f32 v114, v116, v122
    v_sub_f32 v115, v117, v123
    v_add_f32 v116, v116, v122
    v_add_f32 v117, v117, v123
    v_sub_f32 v108, v138, v104
    v_sub_f32 v109, v139, v105
    v_add_f32 v138, v138, v104
    v_add_f32 v139, v139, v105
    v_mul_f32 v110, s22, v108
    v_mul_f32 v111, s23, v108
    v_fma_f32 v108, v109, s23, v110
    v_fma_f32 v109, v109, s22, -v111
    v_sub_f32 v96, v118, v124
    v_sub_f32 v97, v119, v125
    v_add_f32 v118, v118, v124
    v_add_f32 v119, v119, v125
    v_sub_f32 v102, v112, v126
    v_sub_f32 v103, v113, v127
    v_add_f32 v112, v112, v126
    v_add_f32 v113, v113, v127
    v_mul_f32 v128, s22, v102
    v_mul_f32 v129, s23, v102
    v_fma_f32 v102, v103, s23, v128
    v_fma_f32 v103, v103, s22, -v129
    v_sub_f32 v100, v116, v118
    v_sub_f32 v101, v117, v119
    v_add_f32 v116, v116, v118
    v_add_f32 v117, v117, v119
    v_sub_f32 v118, v138, v112
    v_sub_f32 v119, v139, v113
    v_add_f32 v138, v138, v112
    v_add_f32 v139, v139, v113
    v_sub_f32 v112, v116, v138
    v_sub_f32 v113, v117, v139
    v_add_f32 v116, v116, v138
    v_add_f32 v117, v117, v139
    v_sub_f32 v138, v100, v119
    v_add_f32 v139, v101, v118
    v_add_f32 v100, v100, v119
    v_sub_f32 v101, v101, v118
    v_add_f32 v120, v114, v97
    v_sub_f32 v121, v115, v96
    v_sub_f32 v114, v114, v97
    v_add_f32 v115, v115, v96
    v_add_f32 v96, v108, v103
    v_sub_f32 v97, v109, v102
    v_sub_f32 v108, v108, v103
    v_add_f32 v109, v109, v102
    v_sub_f32 v102, v114, v108
    v_sub_f32 v103, v115, v109
    v_add_f32 v114, v114, v108
    v_add_f32 v115, v115, v109
    v_sub_f32 v108, v120, v97
    v_add_f32 v109, v121, v96
    v_add_f32 v120, v120, v97
    v_sub_f32 v121, v121, v96
    ds_write_b64 v13, v[116:117] offset:0
    ds_write_b64 v13, v[114:115] offset:8
    ds_write_b64 v13, v[138:139] offset:16
    ds_write_b64 v13, v[108:109] offset:24
    ds_write_b64 v13, v[112:113] offset:32
    ds_write_b64 v13, v[102:103] offset:40
    ds_write_b64 v13, v[100:101] offset:48
    ds_write_b64 v13, v[120:121] offset:56
    s_branch L_k2_kernel_r0_st3done
L_k2_kernel_r0_mnext:
    s_cmp_eq_u32 s48, 0
    s_cbranch_scc1 L_k2_kernel_r0_st3done
    s_mov_b32 s48, 0
    v_mov_b32 v140, v80
    v_mov_b32 v141, v81
    v_mov_b32 v142, v82
    v_mov_b32 v143, v83
    v_mov_b32 v144, v84
    v_mov_b32 v145, v85
    v_mov_b32 v146, v86
    v_mov_b32 v147, v87
    v_mov_b32 v148, v88
    v_mov_b32 v149, v89
    v_mov_b32 v150, v90
    v_mov_b32 v151, v91
    v_mov_b32 v152, v92
    v_mov_b32 v153, v93
    v_mov_b32 v154, v94
    v_mov_b32 v155, v95
    v_add_u32 v11, 20480, v11
    v_add_u32 v13, 20480, v13
    s_mov_b32 s44, 0
    s_mov_b32 s45, -1.0
    s_branch L_k2_kernel_r0_st3
L_k2_kernel_r0_st3done:
    s_waitcnt lgkmcnt(0)
    s_barrier
    ds_read_b64 v[80:81], v10 offset:0
    ds_read_b64 v[82:83], v10 offset:1280
    ds_read_b64 v[84:85], v10 offset:2560
    ds_read_b64 v[86:87], v10 offset:3840
    ds_read_b64 v[88:89], v10 offset:5120
    ds_read_b64 v[90:91], v10 offset:6400
    ds_read_b64 v[92:93], v10 offset:7680
    ds_read_b64 v[94:95], v10 offset:8960
    ds_read_b64 v[96:97], v10 offset:10240
    ds_read_b64 v[98:99], v10 offset:11520
    ds_read_b64 v[100:101], v10 offset:12800
    ds_read_b64 v[102:103], v10 offset:14080
    ds_read_b64 v[104:105], v10 offset:15360
    ds_read_b64 v[106:107], v10 offset:16640
    ds_read_b64 v[108:109], v10 offset:17920
    ds_read_b64 v[110:111], v10 offset:19200
    s_waitcnt lgkmcnt(0)
    s_barrier
    v_mul_f32 v112, v72, v80
    v_mul_f32 v113, v73, v80
    v_fma_f32 v80, v81, v73, v112
    v_fma_f32 v81, v81, v72, -v113
    v_mul_f32 v114, v42, v82
    v_mul_f32 v115, v43, v82
    v_fma_f32 v82, v83, v43, v114
    v_fma_f32 v83, v83, v42, -v115
    v_mul_f32 v116, v44, v84
    v_mul_f32 v117, v45, v84
    v_fma_f32 v84, v85, v45, v116
    v_fma_f32 v85, v85, v44, -v117
    v_mul_f32 v118, v46, v86
    v_mul_f32 v119, v47, v86
    v_fma_f32 v86, v87, v47, v118
    v_fma_f32 v87, v87, v46, -v119
    v_mul_f32 v120, v48, v88
    v_mul_f32 v121, v49, v88
    v_fma_f32 v88, v89, v49, v120
    v_fma_f32 v89, v89, v48, -v121
    v_mul_f32 v122, v50, v90
    v_mul_f32 v123, v51, v90
    v_fma_f32 v90, v91, v51, v122
    v_fma_f32 v91, v91, v50, -v123
    v_mul_f32 v124, v52, v92
    v_mul_f32 v125, v53, v92
    v_fma_f32 v92, v93, v53, v124
    v_fma_f32 v93, v93, v52, -v125
    v_mul_f32 v126, v54, v94
    v_mul_f32 v127, v55, v94
    v_fma_f32 v94, v95, v55, v126
    v_fma_f32 v95, v95, v54, -v127
    v_mul_f32 v128, v56, v96
    v_mul_f32 v129, v57, v96
    v_fma_f32 v96, v97, v57, v128
    v_fma_f32 v97, v97, v56, -v129
    v_mul_f32 v130, v58, v98
    v_mul_f32 v131, v59, v98
    v_fma_f32 v98, v99, v59, v130
    v_fma_f32 v99, v99, v58, -v131
    v_mul_f32 v132, v60, v100
    v_mul_f32 v133, v61, v100
    v_fma_f32 v100, v101, v61, v132
    v_fma_f32 v101, v101, v60, -v133
    v_mul_f32 v134, v62, v102
    v_mul_f32 v135, v63, v102
    v_fma_f32 v102, v103, v63, v134
    v_fma_f32 v103, v103, v62, -v135
    v_mul_f32 v136, v64, v104
    v_mul_f32 v137, v65, v104
    v_fma_f32 v104, v105, v65, v136
    v_fma_f32 v105, v105, v64, -v137
    v_mul_f32 v138, v66, v106
    v_mul_f32 v139, v67, v106
    v_fma_f32 v106, v107, v67, v138
    v_fma_f32 v107, v107, v66, -v139
    v_mul_f32 v112, v68, v108
    v_mul_f32 v113, v69, v108
    v_fma_f32 v108, v109, v69, v112
    v_fma_f32 v109, v109, v68, -v113
    v_mul_f32 v114, v70, v110
    v_mul_f32 v115, v71, v110
    v_fma_f32 v110, v111, v71, v114
    v_fma_f32 v111, v111, v70, -v115
    v_sub_f32 v116, v80, v96
    v_sub_f32 v117, v81, v97
    v_add_f32 v80, v80, v96
    v_add_f32 v81, v81, v97
    v_sub_f32 v96, v88, v104
    v_sub_f32 v97, v89, v105
    v_add_f32 v88, v88, v104
    v_add_f32 v89, v89, v105
    v_sub_f32 v104, v80, v88
    v_sub_f32 v105, v81, v89
    v_add_f32 v80, v80, v88
    v_add_f32 v81, v81, v89
    v_sub_f32 v88, v116, v97
    v_add_f32 v89, v117, v96
    v_add_f32 v116, v116, v97
    v_sub_f32 v117, v117, v96
    v_sub_f32 v118, v82, v98
    v_sub_f32 v119, v83, v99
    v_add_f32 v82, v82, v98
    v_add_f32 v83, v83, v99
    v_sub_f32 v98, v90, v106
    v_sub_f32 v99, v91, v107
    v_add_f32 v90, v90, v106
    v_add_f32 v91, v91, v107
    v_sub_f32 v106, v82, v90
    v_sub_f32 v107, v83, v91
    v_add_f32 v82, v82, v90
    v_add_f32 v83, v83, v91
    v_sub_f32 v90, v118, v99
    v_add_f32 v91, v119, v98
    v_add_f32 v118, v118, v99
    v_sub_f32 v119, v119, v98
    v_mul_f32 v120, s20, v90
    v_mul_f32 v121, s21, v90
    v_fma_f32 v90, v91, s21, v120
    v_fma_f32 v91, v91, s20, -v121
    v_mul_f32 v122, s22, v106
    v_mul_f32 v123, s23, v106
    v_fma_f32 v106, v107, s23, v122
    v_fma_f32 v107, v107, s22, -v123
    v_mul_f32 v124, s24, v118
    v_mul_f32 v125, s25, v118
    v_fma_f32 v118, v119, s25, v124
    v_fma_f32 v119, v119, s24, -v125
    v_sub_f32 v126, v84, v100
    v_sub_f32 v127, v85, v101
    v_add_f32 v84, v84, v100
    v_add_f32 v85, v85, v101
    v_sub_f32 v100, v92, v108
    v_sub_f32 v101, v93, v109
    v_add_f32 v92, v92, v108
    v_add_f32 v93, v93, v109
    v_sub_f32 v108, v84, v92
    v_sub_f32 v109, v85, v93
    v_add_f32 v84, v84, v92
    v_add_f32 v85, v85, v93
    v_sub_f32 v92, v126, v101
    v_add_f32 v93, v127, v100
    v_add_f32 v126, v126, v101
    v_sub_f32 v127, v127, v100
    v_mul_f32 v128, s22, v92
    v_mul_f32 v129, s23, v92
    v_fma_f32 v92, v93, s23, v128
    v_fma_f32 v93, v93, s22, -v129
    v_mul_f32 v130, s22, v126
    v_mul_f32 v131, s23, v126
    v_fma_f32 v126, v127, s23, v130
    v_fma_f32 v127, v127, s22, -v131
    v_sub_f32 v132, v86, v102
    v_sub_f32 v133, v87, v103
    v_add_f32 v86, v86, v102
    v_add_f32 v87, v87, v103
    v_sub_f32 v102, v94, v110
    v_sub_f32 v103, v95, v111
    v_add_f32 v94, v94, v110
    v_add_f32 v95, v95, v111
    v_sub_f32 v110, v86, v94
    v_sub_f32 v111, v87, v95
    v_add_f32 v86, v86, v94
    v_add_f32 v87, v87, v95
    v_sub_f32 v94, v132, v103
    v_add_f32 v95, v133, v102
    v_add_f32 v132, v132, v103
    v_sub_f32 v133, v133, v102
    v_mul_f32 v134, s24, v94
    v_mul_f32 v135, s25, v94
    v_fma_f32 v94, v95, s25, v134
    v_fma_f32 v95, v95, s24, -v135
    v_mul_f32 v136, s22, v110
    v_mul_f32 v137, s23, v110
    v_fma_f32 v110, v111, s23, v136
    v_fma_f32 v111, v111, s22, -v137
    v_mul_f32 v138, s20, v132
    v_mul_f32 v139, s21, v132
    v_fma_f32 v132, v133, s21, v138
    v_fma_f32 v133, v133, s20, -v139
    v_sub_f32 v112, v80, v84
    v_sub_f32 v113, v81, v85
    v_add_f32 v80, v80, v84
    v_add_f32 v81, v81, v85
    v_sub_f32 v84, v82, v86
    v_sub_f32 v85, v83, v87
    v_add_f32 v82, v82, v86
    v_add_f32 v83, v83, v87
    v_sub_f32 v86, v80, v82
    v_sub_f32 v87, v81, v83
    v_add_f32 v80, v80, v82
    v_add_f32 v81, v81, v83
    v_sub_f32 v82, v112, v85
    v_add_f32 v83, v113, v84
    v_add_f32 v112, v112, v85
    v_sub_f32 v113, v113, v84
    v_sub_f32 v114, v88, v92
    v_sub_f32 v115, v89, v93
    v_add_f32 v88, v88, v92
    v_add_f32 v89, v89, v93
    v_sub_f32 v92, v90, v94
    v_sub_f32 v93, v91, v95
    v_add_f32 v90, v90, v94
    v_add_f32 v91, v91, v95
    v_sub_f32 v94, v88, v90
    v_sub_f32 v95, v89, v91
    v_add_f32 v88, v88, v90
    v_add_f32 v89, v89, v91
    v_sub_f32 v90, v114, v93
    v_add_f32 v91, v115, v92
    v_add_f32 v114, v114, v93
    v_sub_f32 v115, v115, v92
    v_add_f32 v96, v104, v109
    v_sub_f32 v97, v105, v108
    v_sub_f32 v104, v104, v109
    v_add_f32 v105, v105, v108
    v_add_f32 v108, v106, v111
    v_sub_f32 v109, v107, v110
    v_sub_f32 v106, v106, v111
    v_add_f32 v107, v107, v110
    v_sub_f32 v110, v104, v106
    v_sub_f32 v111, v105, v107
    v_add_f32 v104, v104, v106
    v_add_f32 v105, v105, v107
    v_sub_f32 v106, v96, v109
    v_add_f32 v107, v97, v108
    v_add_f32 v96, v96, v109
    v_sub_f32 v97, v97, v108
    v_add_f32 v98, v116, v127
    v_sub_f32 v99, v117, v126
    v_sub_f32 v116, v116, v127
    v_add_f32 v117, v117, v126
    v_add_f32 v126, v118, v132
    v_add_f32 v127, v119, v133
    v_sub_f32 v118, v118, v132
    v_sub_f32 v119, v119, v133
    v_sub_f32 v132, v116, v118
    v_sub_f32 v133, v117, v119
    v_add_f32 v116, v116, v118
    v_add_f32 v117, v117, v119
    v_sub_f32 v118, v98, v127
    v_add_f32 v119, v99, v126
    v_add_f32 v98, v98, v127
    v_sub_f32 v99, v99, v126
    ds_write_b64 v8, v[80:81] offset:0
    ds_write_b64 v8, v[88:89] offset:64
    ds_write_b64 v8, v[104:105] offset:128
    ds_write_b64 v8, v[116:117] offset:192
    ds_write_b64 v8, v[82:83] offset:256
    ds_write_b64 v8, v[90:91] offset:320
    ds_write_b64 v8, v[106:107] offset:384
    ds_write_b64 v8, v[118:119] offset:448
    ds_write_b64 v8, v[86:87] offset:512
    ds_write_b64 v8, v[94:95] offset:576
    ds_write_b64 v8, v[110:111] offset:640
    ds_write_b64 v8, v[132:133] offset:704
    ds_write_b64 v8, v[112:113] offset:768
    ds_write_b64 v8, v[114:115] offset:832
    ds_write_b64 v8, v[96:97] offset:896
    ds_write_b64 v8, v[98:99] offset:960
    v_cos_f32 v42, v4
    v_sin_f32_e64 v43, -v4
    v_mul_f32 v45, 0x40000000, v4
    v_cos_f32 v44, v45
    v_sin_f32_e64 v45, -v45
    v_mul_f32 v47, 0x40400000, v4
    v_cos_f32 v46, v47
    v_sin_f32_e64 v47, -v47
    v_mul_f32 v49, 0x40800000, v4
    v_cos_f32 v48, v49
    v_sin_f32_e64 v49, -v49
    v_mul_f32 v51, 0x40a00000, v4
    v_cos_f32 v50, v51
    v_sin_f32_e64 v51, -v51
    v_mul_f32 v53, 0x40c00000, v4
    v_cos_f32 v52, v53
    v_sin_f32_e64 v53, -v53
    v_mul_f32 v55, 0x40e00000, v4
    v_cos_f32 v54, v55
    v_sin_f32_e64 v55, -v55
    v_mul_f32 v57, 0x41000000, v4
    v_cos_f32 v56, v57
    v_sin_f32_e64 v57, -v57
    v_mul_f32 v59, 0x41100000, v4
    v_cos_f32 v58, v59
    v_sin_f32_e64 v59, -v59
    v_mul_f32 v61, 0x41200000, v4
    v_cos_f32 v60, v61
    v_sin_f32_e64 v61, -v61
    v_mul_f32 v63, 0x41300000, v4
    v_cos_f32 v62, v63
    v_sin_f32_e64 v63, -v63
    v_mul_f32 v65, 0x41400000, v4
    v_cos_f32 v64, v65
    v_sin_f32_e64 v65, -v65
    v_mul_f32 v67, 0x41500000, v4
    v_cos_f32 v66, v67
    v_sin_f32_e64 v67, -v67
    v_mul_f32 v69, 0x41600000, v4
    v_cos_f32 v68, v69
    v_sin_f32_e64 v69, -v69
    v_mul_f32 v71, 0x41700000, v4
    v_cos_f32 v70, v71
    v_sin_f32_e64 v71, -v71
    s_waitcnt lgkmcnt(0)
    s_barrier
    ds_read_b64 v[120:121], v5 offset:0
    ds_read_b64 v[122:123], v5 offset:1088
    ds_read_b64 v[124:125], v5 offset:2176
    ds_read_b64 v[100:101], v5 offset:3264
    ds_read_b64 v[128:129], v5 offset:4352
    ds_read_b64 v[130:131], v5 offset:5440
    ds_read_b64 v[102:103], v5 offset:6528
    ds_read_b64 v[134:135], v5 offset:7616
    ds_read_b64 v[136:137], v5 offset:8704
    ds_read_b64 v[138:139], v5 offset:9792
    ds_read_b64 v[84:85], v5 offset:10880
    ds_read_b64 v[92:93], v5 offset:11968
    ds_read_b64 v[108:109], v5 offset:13056
    ds_read_b64 v[126:127], v5 offset:14144
    ds_read_b64 v[80:81], v5 offset:15232
    ds_read_b64 v[88:89], v5 offset:16320
    v_lshlrev_b32 v3, 2, v2
    s_lshl_b32 s19, s18, 13
    s_add_u32 s19, s19, 16777216
    s_waitcnt lgkmcnt(0)
    v_mul_f32 v104, v42, v122
    v_mul_f32 v105, v43, v122
    v_fma_f32 v122, v123, v43, v104
    v_fma_f32 v123, v123, v42, -v105
    v_mul_f32 v116, v44, v124
    v_mul_f32 v117, v45, v124
    v_fma_f32 v124, v125, v45, v116
    v_fma_f32 v125, v125, v44, -v117
    v_mul_f32 v82, v46, v100
    v_mul_f32 v83, v47, v100
    v_fma_f32 v100, v101, v47, v82
    v_fma_f32 v101, v101, v46, -v83
    v_mul_f32 v90, v48, v128
    v_mul_f32 v91, v49, v128
    v_fma_f32 v128, v129, v49, v90
    v_fma_f32 v129, v129, v48, -v91
    v_mul_f32 v106, v50, v130
    v_mul_f32 v107, v51, v130
    v_fma_f32 v130, v131, v51, v106
    v_fma_f32 v131, v131, v50, -v107
    v_mul_f32 v118, v52, v102
    v_mul_f32 v119, v53, v102
    v_fma_f32 v102, v103, v53, v118
    v_fma_f32 v103, v103, v52, -v119
    v_mul_f32 v86, v54, v134
    v_mul_f32 v87, v55, v134
    v_fma_f32 v134, v135, v55, v86
    v_fma_f32 v135, v135, v54, -v87
    v_mul_f32 v94, v56, v136
    v_mul_f32 v95, v57, v136
    v_fma_f32 v136, v137, v57, v94
    v_fma_f32 v137, v137, v56, -v95
    v_mul_f32 v110, v58, v138
    v_mul_f32 v111, v59, v138
    v_fma_f32 v138, v139, v59, v110
    v_fma_f32 v139, v139, v58, -v111
    v_mul_f32 v132, v60, v84
    v_mul_f32 v133, v61, v84
    v_fma_f32 v84, v85, v61, v132
    v_fma_f32 v85, v85, v60, -v133
    v_mul_f32 v112, v62, v92
    v_mul_f32 v113, v63, v92
    v_fma_f32 v92, v93, v63, v112
    v_fma_f32 v93, v93, v62, -v113
    v_mul_f32 v114, v64, v108
    v_mul_f32 v115, v65, v108
    v_fma_f32 v108, v109, v65, v114
    v_fma_f32 v109, v109, v64, -v115
    v_mul_f32 v96, v66, v126
    v_mul_f32 v97, v67, v126
    v_fma_f32 v126, v127, v67, v96
    v_fma_f32 v127, v127, v66, -v97
    v_mul_f32 v98, v68, v80
    v_mul_f32 v99, v69, v80
    v_fma_f32 v80, v81, v69, v98
    v_fma_f32 v81, v81, v68, -v99
    v_mul_f32 v104, v70, v88
    v_mul_f32 v105, v71, v88
    v_fma_f32 v88, v89, v71, v104
    v_fma_f32 v89, v89, v70, -v105
    v_sub_f32 v116, v120, v136
    v_sub_f32 v117, v121, v137
    v_add_f32 v120, v120, v136
    v_add_f32 v121, v121, v137
    v_sub_f32 v136, v128, v108
    v_sub_f32 v137, v129, v109
    v_add_f32 v128, v128, v108
    v_add_f32 v129, v129, v109
    v_sub_f32 v108, v120, v128
    v_sub_f32 v109, v121, v129
    v_add_f32 v120, v120, v128
    v_add_f32 v121, v121, v129
    v_sub_f32 v128, v116, v137
    v_add_f32 v129, v117, v136
    v_add_f32 v116, v116, v137
    v_sub_f32 v117, v117, v136
    v_sub_f32 v82, v122, v138
    v_sub_f32 v83, v123, v139
    v_add_f32 v122, v122, v138
    v_add_f32 v123, v123, v139
    v_sub_f32 v138, v130, v126
    v_sub_f32 v139, v131, v127
    v_add_f32 v130, v130, v126
    v_add_f32 v131, v131, v127
    v_sub_f32 v126, v122, v130
    v_sub_f32 v127, v123, v131
    v_add_f32 v122, v122, v130
    v_add_f32 v123, v123, v131
    v_sub_f32 v130, v82, v139
    v_add_f32 v131, v83, v138
    v_add_f32 v82, v82, v139
    v_sub_f32 v83, v83, v138
    v_mul_f32 v90, s20, v130
    v_mul_f32 v91, s21, v130
    v_fma_f32 v130, v131, s21, v90
    v_fma_f32 v131, v131, s20, -v91
    v_mul_f32 v106, s22, v126
    v_mul_f32 v107, s23, v126
    v_fma_f32 v126, v127, s23, v106
    v_fma_f32 v127, v127, s22, -v107
    v_mul_f32 v118, s24, v82
    v_mul_f32 v119, s25, v82
    v_fma_f32 v82, v83, s25, v118
    v_fma_f32 v83, v83, s24, -v119
    v_sub_f32 v86, v124, v84
    v_sub_f32 v87, v125, v85
    v_add_f32 v124, v124, v84
    v_add_f32 v125, v125, v85
    v_sub_f32 v84, v102, v80
    v_sub_f32 v85, v103, v81
    v_add_f32 v102, v102, v80
    v_add_f32 v103, v103, v81
    v_sub_f32 v80, v124, v102
    v_sub_f32 v81, v125, v103
    v_add_f32 v124, v124, v102
    v_add_f32 v125, v125, v103
    v_sub_f32 v102, v86, v85
    v_add_f32 v103, v87, v84
    v_add_f32 v86, v86, v85
    v_sub_f32 v87, v87, v84
    v_mul_f32 v94, s22, v102
    v_mul_f32 v95, s23, v102
    v_fma_f32 v102, v103, s23, v94
    v_fma_f32 v103, v103, s22, -v95
    v_mul_f32 v110, s22, v86
    v_mul_f32 v111, s23, v86
    v_fma_f32 v86, v87, s23, v110
    v_fma_f32 v87, v87, s22, -v111
    v_sub_f32 v132, v100, v92
    v_sub_f32 v133, v101, v93
    v_add_f32 v100, v100, v92
    v_add_f32 v101, v101, v93
    v_sub_f32 v92, v134, v88
    v_sub_f32 v93, v135, v89
    v_add_f32 v134, v134, v88
    v_add_f32 v135, v135, v89
    v_sub_f32 v88, v100, v134
    v_sub_f32 v89, v101, v135
    v_add_f32 v100, v100, v134
    v_add_f32 v101, v101, v135
    v_sub_f32 v134, v132, v93
    v_add_f32 v135, v133, v92
    v_add_f32 v132, v132, v93
    v_sub_f32 v133, v133, v92
    v_mul_f32 v112, s24, v134
    v_mul_f32 v113, s25, v134
    v_fma_f32 v134, v135, s25, v112
    v_fma_f32 v135, v135, s24, -v113
    v_mul_f32 v114, s22, v88
    v_mul_f32 v115, s23, v88
    v_fma_f32 v88, v89, s23, v114
    v_fma_f32 v89, v89, s22, -v115
    v_mul_f32 v96, s20, v132
    v_mul_f32 v97, s21, v132
    v_fma_f32 v132, v133, s21, v96
    v_fma_f32 v133, v133, s20, -v97
    v_sub_f32 v98, v120, v124
    v_sub_f32 v99, v121, v125
    v_add_f32 v120, v120, v124
    v_add_f32 v121, v121, v125
    v_sub_f32 v124, v122, v100
    v_sub_f32 v125, v123, v101
    v_add_f32 v122, v122, v100
    v_add_f32 v123, v123, v101
    v_sub_f32 v100, v120, v122
    v_sub_f32 v101, v121, v123
    v_add_f32 v120, v120, v122
    v_add_f32 v121, v121, v123
    v_sub_f32 v122, v98, v125
    v_add_f32 v123, v99, v124
    v_add_f32 v98, v98, v125
    v_sub_f32 v99, v99, v124
    v_sub_f32 v104, v128, v102
    v_sub_f32 v105, v129, v103
    v_add_f32 v128, v128, v102
    v_add_f32 v129, v129, v103
    v_sub_f32 v102, v130, v134
    v_sub_f32 v103, v131, v135
    v_add_f32 v130, v130, v134
    v_add_f32 v131, v131, v135
    v_sub_f32 v134, v128, v130
    v_sub_f32 v135, v129, v131
    v_add_f32 v128, v128, v130
    v_add_f32 v129, v129, v131
    v_sub_f32 v130, v104, v103
    v_add_f32 v131, v105, v102
    v_add_f32 v104, v104, v103
    v_sub_f32 v105, v105, v102
    v_add_f32 v136, v108, v81
    v_sub_f32 v137, v109, v80
    v_sub_f32 v108, v108, v81
    v_add_f32 v109, v109, v80
    v_add_f32 v80, v126, v89
    v_sub_f32 v81, v127, v88
    v_sub_f32 v126, v126, v89
    v_add_f32 v127, v127, v88
    v_sub_f32 v88, v108, v126
    v_sub_f32 v89, v109, v127
    v_add_f32 v108, v108, v126
    v_add_f32 v109, v109, v127
    v_sub_f32 v126, v136, v81
    v_add_f32 v127, v137, v80
    v_add_f32 v136, v136, v81
    v_sub_f32 v137, v137, v80
    v_add_f32 v138, v116, v87
    v_sub_f32 v139, v117, v86
    v_sub_f32 v116, v116, v87
    v_add_f32 v117, v117, v86
    v_add_f32 v86, v82, v132
    v_add_f32 v87, v83, v133
    v_sub_f32 v82, v82, v132
    v_sub_f32 v83, v83, v133
    v_sub_f32 v132, v116, v82
    v_sub_f32 v133, v117, v83
    v_add_f32 v116, v116, v82
    v_add_f32 v117, v117, v83
    v_sub_f32 v82, v138, v87
    v_add_f32 v83, v139, v86
    v_add_f32 v138, v138, v87
    v_sub_f32 v139, v139, v86
    v_cvt_pk_bf16_f32 v120, v120, v121
    buffer_store_dword v120, v3, s[12:15], s19 offen offset:0 sc1
    v_cvt_pk_bf16_f32 v128, v128, v129
    buffer_store_dword v128, v3, s[12:15], s19 offen offset:512 sc1
    v_cvt_pk_bf16_f32 v108, v108, v109
    buffer_store_dword v108, v3, s[12:15], s19 offen offset:1024 sc1
    v_cvt_pk_bf16_f32 v116, v116, v117
    buffer_store_dword v116, v3, s[12:15], s19 offen offset:1536 sc1
    v_cvt_pk_bf16_f32 v122, v122, v123
    buffer_store_dword v122, v3, s[12:15], s19 offen offset:2048 sc1
    v_cvt_pk_bf16_f32 v130, v130, v131
    buffer_store_dword v130, v3, s[12:15], s19 offen offset:2560 sc1
    v_cvt_pk_bf16_f32 v126, v126, v127
    buffer_store_dword v126, v3, s[12:15], s19 offen offset:3072 sc1
    v_cvt_pk_bf16_f32 v82, v82, v83
    buffer_store_dword v82, v3, s[12:15], s19 offen offset:3584 sc1
    s_add_u32 s19, s19, 4096
    v_cvt_pk_bf16_f32 v100, v100, v101
    buffer_store_dword v100, v3, s[12:15], s19 offen offset:0 sc1
    v_cvt_pk_bf16_f32 v134, v134, v135
    buffer_store_dword v134, v3, s[12:15], s19 offen offset:512 sc1
    v_cvt_pk_bf16_f32 v88, v88, v89
    buffer_store_dword v88, v3, s[12:15], s19 offen offset:1024 sc1
    v_cvt_pk_bf16_f32 v132, v132, v133
    buffer_store_dword v132, v3, s[12:15], s19 offen offset:1536 sc1
    v_cvt_pk_bf16_f32 v98, v98, v99
    buffer_store_dword v98, v3, s[12:15], s19 offen offset:2048 sc1
    v_cvt_pk_bf16_f32 v104, v104, v105
    buffer_store_dword v104, v3, s[12:15], s19 offen offset:2560 sc1
    v_cvt_pk_bf16_f32 v136, v136, v137
    buffer_store_dword v136, v3, s[12:15], s19 offen offset:3072 sc1
    v_cvt_pk_bf16_f32 v138, v138, v139
    buffer_store_dword v138, v3, s[12:15], s19 offen offset:3584 sc1
    s_endpgm
.p2align 6
L_k2_kernel_r1:
    s_mov_b32 s57, 71827456
    s_load_dwordx2 s[76:77], s[0:1], 72
    s_load_dwordx2 s[80:81], s[0:1], 96
    v_lshrrev_b32 v1, 6, v0
    s_nop 0
    v_readfirstlane_b32 s30, v1
    v_and_b32 v2, 63, v0
    s_lshr_b32 s26, s30, 1
    s_and_b32 s27, s30, 1
    s_lshl_b32 s31, s2, 1
    s_add_u32 s31, s31, s26
    s_mul_i32 s48, s26, 24336
    s_add_u32 s59, s48, 7680
    s_waitcnt lgkmcnt(0)
    s_mov_b32 s36, s76
    s_mov_b32 s37, s77
    s_mov_b32 s38, 2048
    s_mov_b32 s39, 0x00020000
    s_mov_b32 s44, s80
    s_mov_b32 s45, s81
    s_mov_b32 s46, 268435456
    s_mov_b32 s47, 0x00020000
    v_lshlrev_b32 v3, 4, v2
    s_lshl_b32 s49, s31, 12
    s_lshl_b32 s24, s27, 11
    s_add_u32 s49, s49, s24
    s_add_u32 s50, s49, 41943040
    buffer_load_dwordx4 v[112:115], v3, s[44:47], s50 offen offset:0
    buffer_load_dwordx4 v[116:119], v3, s[44:47], s50 offen offset:1024
    v_lshlrev_b32 v26, 3, v2
    s_mul_i32 s51, s31, 1408
    s_add_u32 s51, s51, 50331648
    s_lshl_b32 s25, s27, 9
    buffer_load_dwordx4 v[120:123], v3, s[44:47], s51 offen
    buffer_load_dwordx4 v[124:127], v3, s[44:47], s51 offen offset:1024
    v_mov_b32 v4, 0
    s_lshl_b32 s53, s31, 1
    buffer_load_ushort v15, v4, s[36:39], s53 offen
    v_mov_b32 v20, 0
    v_mov_b32 v21, 0
    v_mov_b32 v22, 0
    v_mov_b32 v23, 0
    s_mul_i32 s24, s27, 1280
    s_add_u32 s24, s24, s48
    v_add_u32 v6, s24, v3
    ds_write_b128 v6, v[20:23]
    s_mov_b64 exec, 0xffff
    ds_write_b128 v6, v[20:23] offset:1024
    s_mov_b64 exec, -1
    v_lshrrev_b32 v7, 2, v2
    v_mul_u32_u24 v7, 80, v7
    v_and_b32 v8, 3, v2
    v_lshl_add_u32 v7, v8, 4, v7
    s_mul_i32 s24, s27, 2560
    s_add_u32 s22, s24, s48
    v_add_u32 v9, s22, v7
    s_add_u32 s23, s59, s25
    v_add_u32 v23, s23, v26
    s_add_u32 s58, s59, 14400
    v_add_u32 v10, s58, v3
    s_sub_u32 s56, s58, 34048
    v_lshlrev_b32 v24, 2, v2
    s_lshl_b32 s24, s27, 8
    v_add_u32 v24, s24, v24
    v_cvt_f32_u32 v22, v24
    v_add_u32 v25, -32, v24
    v_max_i32 v25, 0, v25
    v_cvt_f32_u32 v27, v25
    v_cvt_pk_bf16_f32 v27, v27, v27
    v_and_b32 v27, 0xffff, v27
    v_subrev_u32 v27, 17024, v27
    v_cmp_gt_u32 vcc, 128, v25
    s_nop 1
    v_cndmask_b32 v25, v27, v25, vcc
    v_lshl_add_u32 v128, v25, 1, s58
    v_add_u32 v25, -31, v24
    v_max_i32 v25, 0, v25
    v_cvt_f32_u32 v27, v25
    v_cvt_pk_bf16_f32 v27, v27, v27
    v_and_b32 v27, 0xffff, v27
    v_subrev_u32 v27, 17024, v27
    v_cmp_gt_u32 vcc, 128, v25
    s_nop 1
    v_cndmask_b32 v25, v27, v25, vcc
    v_lshl_add_u32 v129, v25, 1, s58
    v_add_u32 v25, -30, v24
    v_max_i32 v25, 0, v25
    v_cvt_f32_u32 v27, v25
    v_cvt_pk_bf16_f32 v27, v27, v27
    v_and_b32 v27, 0xffff, v27
    v_subrev_u32 v27, 17024, v27
    v_cmp_gt_u32 vcc, 128, v25
    s_nop 1
    v_cndmask_b32 v25, v27, v25, vcc
    v_lshl_add_u32 v130, v25, 1, s58
    v_add_u32 v25, -29, v24
    v_max_i32 v25, 0, v25
    v_cvt_f32_u32 v27, v25
    v_cvt_pk_bf16_f32 v27, v27, v27
    v_and_b32 v27, 0xffff, v27
    v_subrev_u32 v27, 17024, v27
    v_cmp_gt_u32 vcc, 128, v25
    s_nop 1
    v_cndmask_b32 v25, v27, v25, vcc
    v_lshl_add_u32 v131, v25, 1, s58
    v_add_f32 v25, 0x43f00000, v22
    v_add_f32 v26, 0x43f08000, v22
    v_cvt_pk_bf16_f32 v25, v25, v26
    v_lshrrev_b32 v26, 16, v25
    v_and_b32 v25, 0xffff, v25
    v_lshl_add_u32 v132, v25, 1, s56
    v_lshl_add_u32 v133, v26, 1, s56
    v_add_f32 v25, 0x43f10000, v22
    v_add_f32 v26, 0x43f18000, v22
    v_cvt_pk_bf16_f32 v25, v25, v26
    v_lshrrev_b32 v26, 16, v25
    v_and_b32 v25, 0xffff, v25
    v_lshl_add_u32 v134, v25, 1, s56
    v_lshl_add_u32 v135, v26, 1, s56
    v_add_f32 v25, 0x44780000, v22
    v_add_f32 v26, 0x44784000, v22
    v_cvt_pk_bf16_f32 v25, v25, v26
    v_lshrrev_b32 v26, 16, v25
    v_and_b32 v25, 0xffff, v25
    v_lshl_add_u32 v136, v25, 1, s56
    v_lshl_add_u32 v137, v26, 1, s56
    v_add_f32 v25, 0x44788000, v22
    v_add_f32 v26, 0x4478c000, v22
    v_cvt_pk_bf16_f32 v25, v25, v26
    v_lshrrev_b32 v26, 16, v25
    v_and_b32 v25, 0xffff, v25
    v_lshl_add_u32 v138, v25, 1, s56
    v_lshl_add_u32 v139, v26, 1, s56
    v_add_f32 v25, 0x44bc0000, v22
    v_add_f32 v26, 0x44bc2000, v22
    v_cvt_pk_bf16_f32 v25, v25, v26
    v_lshrrev_b32 v26, 16, v25
    v_and_b32 v25, 0xffff, v25
    v_lshl_add_u32 v140, v25, 1, s56
    v_lshl_add_u32 v141, v26, 1, s56
    v_add_f32 v25, 0x44bc4000, v22
    v_add_f32 v26, 0x44bc6000, v22
    v_cvt_pk_bf16_f32 v25, v25, v26
    v_lshrrev_b32 v26, 16, v25
    v_and_b32 v25, 0xffff, v25
    v_lshl_add_u32 v142, v25, 1, s56
    v_lshl_add_u32 v143, v26, 1, s56
    v_add_f32 v25, 0x44fc0000, v22
    v_add_f32 v26, 0x44fc2000, v22
    v_min_f32 v25, 0x44ffe000, v25
    v_min_f32 v26, 0x44ffe000, v26
    v_cvt_pk_bf16_f32 v25, v25, v26
    v_lshrrev_b32 v26, 16, v25
    v_and_b32 v25, 0xffff, v25
    v_lshl_add_u32 v144, v25, 1, s56
    v_lshl_add_u32 v145, v26, 1, s56
    v_add_f32 v25, 0x44fc4000, v22
    v_add_f32 v26, 0x44fc6000, v22
    v_min_f32 v25, 0x44ffe000, v25
    v_min_f32 v26, 0x44ffe000, v26
    v_cvt_pk_bf16_f32 v25, v25, v26
    v_lshrrev_b32 v26, 16, v25
    v_and_b32 v25, 0xffff, v25
    v_lshl_add_u32 v146, v25, 1, s56
    v_lshl_add_u32 v147, v26, 1, s56
    v_and_b32 v16, 31, v2
    v_lshrrev_b32 v17, 5, v2
    v_add_u32 v18, 1, v16
    v_and_b32 v18, 3, v18
    v_mul_u32_u24 v19, 4160, v18
    v_cmp_lt_u32 vcc, 0, v18
    s_nop 1
    v_cndmask_b32_e64 v20, 0, 8, vcc
    v_add_u32 v19, v19, v20
    v_lshlrev_b32 v20, 3, v17
    v_sub_u32 v21, v16, v20
    v_sub_u32 v21, v21, v18
    v_add_u32 v21, 9, v21
    v_lshl_add_u32 v19, v21, 1, v19
    s_lshl_b32 s24, s27, 5
    s_sub_u32 s22, s59, s24
    v_add_u32 v19, s22, v19
    v_mul_u32_u24 v20, 80, v16
    v_lshl_add_u32 v20, v17, 4, v20
    v_add_u32 v20, 80, v20
    s_add_u32 s22, s48, s24
    v_add_u32 v20, s22, v20
    v_mov_b32 v32, 0
    v_mov_b32 v33, 0
    v_mov_b32 v34, 0
    v_mov_b32 v35, 0
    v_mov_b32 v36, 0
    v_mov_b32 v37, 0
    v_mov_b32 v38, 0
    v_mov_b32 v39, 0
    v_mov_b32 v40, 0
    v_mov_b32 v41, 0
    v_mov_b32 v42, 0
    v_mov_b32 v43, 0
    v_mov_b32 v44, 0
    v_mov_b32 v45, 0
    v_mov_b32 v46, 0
    v_mov_b32 v47, 0
    v_mov_b32 v48, 0
    v_mov_b32 v49, 0
    v_mov_b32 v50, 0
    v_mov_b32 v51, 0
    v_mov_b32 v52, 0
    v_mov_b32 v53, 0
    v_mov_b32 v54, 0
    v_mov_b32 v55, 0
    v_mov_b32 v56, 0
    v_mov_b32 v57, 0
    v_mov_b32 v58, 0
    v_mov_b32 v59, 0
    v_mov_b32 v60, 0
    v_mov_b32 v61, 0
    v_mov_b32 v62, 0
    v_mov_b32 v63, 0
    s_waitcnt vmcnt(1)
    ds_write_b128 v10, v[120:123]
    s_mov_b64 exec, 0x3ffff
    ds_write_b128 v10, v[124:127] offset:1024
    s_mov_b64 exec, -1
    ds_read_u16_d16 v64, v128
    ds_read_u16_d16_hi v80, v129
    ds_read_u16_d16 v65, v130
    ds_read_u16_d16_hi v81, v131
    ds_read_u16_d16 v66, v132
    ds_read_u16_d16_hi v82, v133
    ds_read_u16_d16 v67, v134
    ds_read_u16_d16_hi v83, v135
    ds_read_u16_d16 v68, v136
    ds_read_u16_d16_hi v84, v137
    ds_read_u16_d16 v69, v138
    ds_read_u16_d16_hi v85, v139
    ds_read_u16_d16 v70, v140
    ds_read_u16_d16_hi v86, v141
    ds_read_u16_d16 v71, v142
    ds_read_u16_d16_hi v87, v143
    ds_read_u16_d16 v72, v144
    ds_read_u16_d16_hi v88, v145
    ds_read_u16_d16 v73, v146
    ds_read_u16_d16_hi v89, v147
    ds_write_b128 v9, v[112:115] offset:2560
    ds_write_b128 v9, v[116:119] offset:3840
    s_waitcnt lgkmcnt(0)
    v_or_b32 v64, v64, v80
    v_or_b32 v65, v65, v81
    v_or_b32 v66, v66, v82
    v_or_b32 v67, v67, v83
    v_or_b32 v68, v68, v84
    v_or_b32 v69, v69, v85
    v_or_b32 v70, v70, v86
    v_or_b32 v71, v71, v87
    v_or_b32 v72, v72, v88
    v_or_b32 v73, v73, v89
    v_cmp_gt_u32 vcc, 32, v24
    s_nop 1
    v_cndmask_b32_e64 v64, v64, 0, vcc
    v_cndmask_b32_e64 v65, v65, 0, vcc
    ds_write_b64 v23, v[64:65] offset:0
    ds_write_b64 v23, v[66:67] offset:1024
    ds_write_b64 v23, v[68:69] offset:2048
    ds_write_b64 v23, v[70:71] offset:3072
    s_cmp_eq_u32 s27, 1
    s_cbranch_scc1 L_k2_kernel_r1_c0
    s_mov_b64 exec, 0xff
    ds_write_b64 v23, v[72:73] offset:4096
    s_mov_b64 exec, -1
L_k2_kernel_r1_c0:
    s_waitcnt lgkmcnt(0)
    s_barrier
    ds_read_b64 v[80:81], v23 offset:8
    ds_read_b64 v[82:83], v23 offset:1032
    ds_read_b64 v[84:85], v23 offset:2056
    ds_read_b64 v[86:87], v23 offset:3080
    ds_read_b64 v[88:89], v23 offset:4104
    s_waitcnt lgkmcnt(0)
    v_alignbit_b32 v26, v65, v64, 16
    v_alignbit_b32 v27, v80, v65, 16
    v_mov_b32 v28, v27
    v_alignbit_b32 v29, v81, v80, 16
    ds_write_b64 v23, v[26:27] offset:4168
    v_mov_b32 v30, v65
    v_mov_b32 v31, v80
    ds_write_b64 v23, v[30:31] offset:8328
    ds_write_b64 v23, v[28:29] offset:12488
    v_alignbit_b32 v26, v67, v66, 16
    v_alignbit_b32 v27, v82, v67, 16
    v_mov_b32 v28, v27
    v_alignbit_b32 v29, v83, v82, 16
    ds_write_b64 v23, v[26:27] offset:5192
    v_mov_b32 v30, v67
    v_mov_b32 v31, v82
    ds_write_b64 v23, v[30:31] offset:9352
    ds_write_b64 v23, v[28:29] offset:13512
    v_alignbit_b32 v26, v69, v68, 16
    v_alignbit_b32 v27, v84, v69, 16
    v_mov_b32 v28, v27
    v_alignbit_b32 v29, v85, v84, 16
    ds_write_b64 v23, v[26:27] offset:6216
    v_mov_b32 v30, v69
    v_mov_b32 v31, v84
    ds_write_b64 v23, v[30:31] offset:10376
    ds_write_b64 v23, v[28:29] offset:14536
    v_alignbit_b32 v26, v71, v70, 16
    v_alignbit_b32 v27, v86, v71, 16
    v_mov_b32 v28, v27
    v_alignbit_b32 v29, v87, v86, 16
    ds_write_b64 v23, v[26:27] offset:7240
    v_mov_b32 v30, v71
    v_mov_b32 v31, v86
    ds_write_b64 v23, v[30:31] offset:11400
    ds_write_b64 v23, v[28:29] offset:15560
    s_cmp_eq_u32 s27, 1
    s_cbranch_scc1 L_k2_kernel_r1_kdone
    s_mov_b64 exec, 0x7f
    v_alignbit_b32 v26, v73, v72, 16
    v_alignbit_b32 v27, v88, v73, 16
    v_mov_b32 v28, v27
    v_alignbit_b32 v29, v89, v88, 16
    ds_write_b64 v23, v[26:27] offset:8264
    v_mov_b32 v30, v73
    v_mov_b32 v31, v88
    ds_write_b64 v23, v[30:31] offset:12424
    ds_write_b64 v23, v[28:29] offset:16584
    s_mov_b64 exec, -1
L_k2_kernel_r1_kdone:
    s_waitcnt lgkmcnt(0)
    s_barrier
    ds_read_b64 v[64:65], v19 offset:32
    ds_read_b64 v[66:67], v19 offset:40
    ds_read_b128 v[68:71], v20 offset:2480
    ds_read_b128 v[72:75], v20 offset:5040
    ds_read_b64 v[76:77], v19 offset:96
    ds_read_b64 v[78:79], v19 offset:104
    ds_read_b128 v[80:83], v20 offset:2400
    ds_read_b128 v[84:87], v20 offset:4960
    ds_read_b64 v[88:89], v19 offset:160
    ds_read_b64 v[90:91], v19 offset:168
    ds_read_b128 v[92:95], v20 offset:2320
    ds_read_b128 v[96:99], v20 offset:4880
    ds_read_b64 v[100:101], v19 offset:224
    ds_read_b64 v[102:103], v19 offset:232
    ds_read_b128 v[104:107], v20 offset:2240
    ds_read_b128 v[108:111], v20 offset:4800
    s_waitcnt lgkmcnt(12)
    v_mfma_f32_32x32x16_bf16 v[32:47], v[64:67], v[68:71], v[32:47]
    v_mfma_f32_32x32x16_bf16 v[48:63], v[64:67], v[72:75], v[48:63]
    ds_read_b64 v[64:65], v19 offset:288
    ds_read_b64 v[66:67], v19 offset:296
    ds_read_b128 v[68:71], v20 offset:2160
    ds_read_b128 v[72:75], v20 offset:4720
    s_waitcnt lgkmcnt(12)
    v_mfma_f32_32x32x16_bf16 v[32:47], v[76:79], v[80:83], v[32:47]
    v_mfma_f32_32x32x16_bf16 v[48:63], v[76:79], v[84:87], v[48:63]
    ds_read_b64 v[76:77], v19 offset:352
    ds_read_b64 v[78:79], v19 offset:360
    ds_read_b128 v[80:83], v20 offset:2080
    ds_read_b128 v[84:87], v20 offset:4640
    s_waitcnt lgkmcnt(12)
    v_mfma_f32_32x32x16_bf16 v[32:47], v[88:91], v[92:95], v[32:47]
    v_mfma_f32_32x32x16_bf16 v[48:63], v[88:91], v[96:99], v[48:63]
    ds_read_b64 v[88:89], v19 offset:416
    ds_read_b64 v[90:91], v19 offset:424
    ds_read_b128 v[92:95], v20 offset:2000
    ds_read_b128 v[96:99], v20 offset:4560
    s_waitcnt lgkmcnt(12)
    v_mfma_f32_32x32x16_bf16 v[32:47], v[100:103], v[104:107], v[32:47]
    v_mfma_f32_32x32x16_bf16 v[48:63], v[100:103], v[108:111], v[48:63]
    ds_read_b64 v[100:101], v19 offset:480
    ds_read_b64 v[102:103], v19 offset:488
    ds_read_b128 v[104:107], v20 offset:1920
    ds_read_b128 v[108:111], v20 offset:4480
    s_waitcnt lgkmcnt(12)
    v_mfma_f32_32x32x16_bf16 v[32:47], v[64:67], v[68:71], v[32:47]
    v_mfma_f32_32x32x16_bf16 v[48:63], v[64:67], v[72:75], v[48:63]
    ds_read_b64 v[64:65], v19 offset:544
    ds_read_b64 v[66:67], v19 offset:552
    ds_read_b128 v[68:71], v20 offset:1840
    ds_read_b128 v[72:75], v20 offset:4400
    s_waitcnt lgkmcnt(12)
    v_mfma_f32_32x32x16_bf16 v[32:47], v[76:79], v[80:83], v[32:47]
    v_mfma_f32_32x32x16_bf16 v[48:63], v[76:79], v[84:87], v[48:63]
    ds_read_b64 v[76:77], v19 offset:608
    ds_read_b64 v[78:79], v19 offset:616
    ds_read_b128 v[80:83], v20 offset:1760
    ds_read_b128 v[84:87], v20 offset:4320
    s_waitcnt lgkmcnt(12)
    v_mfma_f32_32x32x16_bf16 v[32:47], v[88:91], v[92:95], v[32:47]
    v_mfma_f32_32x32x16_bf16 v[48:63], v[88:91], v[96:99], v[48:63]
    ds_read_b64 v[88:89], v19 offset:672
    ds_read_b64 v[90:91], v19 offset:680
    ds_read_b128 v[92:95], v20 offset:1680
    ds_read_b128 v[96:99], v20 offset:4240
    s_waitcnt lgkmcnt(12)
    v_mfma_f32_32x32x16_bf16 v[32:47], v[100:103], v[104:107], v[32:47]
    v_mfma_f32_32x32x16_bf16 v[48:63], v[100:103], v[108:111], v[48:63]
    ds_read_b64 v[100:101], v19 offset:736
    ds_read_b64 v[102:103], v19 offset:744
    ds_read_b128 v[104:107], v20 offset:1600
    ds_read_b128 v[108:111], v20 offset:4160
    s_waitcnt lgkmcnt(12)
    v_mfma_f32_32x32x16_bf16 v[32:47], v[64:67], v[68:71], v[32:47]
    v_mfma_f32_32x32x16_bf16 v[48:63], v[64:67], v[72:75], v[48:63]
    ds_read_b64 v[64:65], v19 offset:800
    ds_read_b64 v[66:67], v19 offset:808
    ds_read_b128 v[68:71], v20 offset:1520
    ds_read_b128 v[72:75], v20 offset:4080
    s_waitcnt lgkmcnt(12)
    v_mfma_f32_32x32x16_bf16 v[32:47], v[76:79], v[80:83], v[32:47]
    v_mfma_f32_32x32x16_bf16 v[48:63], v[76:79], v[84:87], v[48:63]
    ds_read_b64 v[76:77], v19 offset:864
    ds_read_b64 v[78:79], v19 offset:872
    ds_read_b128 v[80:83], v20 offset:1440
    ds_read_b128 v[84:87], v20 offset:4000
    s_waitcnt lgkmcnt(12)
    v_mfma_f32_32x32x16_bf16 v[32:47], v[88:91], v[92:95], v[32:47]
    v_mfma_f32_32x32x16_bf16 v[48:63], v[88:91], v[96:99], v[48:63]
    ds_read_b64 v[88:89], v19 offset:928
    ds_read_b64 v[90:91], v19 offset:936
    ds_read_b128 v[92:95], v20 offset:1360
    ds_read_b128 v[96:99], v20 offset:3920
    s_waitcnt lgkmcnt(12)
    v_mfma_f32_32x32x16_bf16 v[32:47], v[100:103], v[104:107], v[32:47]
    v_mfma_f32_32x32x16_bf16 v[48:63], v[100:103], v[108:111], v[48:63]
    ds_read_b64 v[100:101], v19 offset:992
    ds_read_b64 v[102:103], v19 offset:1000
    ds_read_b128 v[104:107], v20 offset:1280
    ds_read_b128 v[108:111], v20 offset:3840
    s_waitcnt lgkmcnt(12)
    v_mfma_f32_32x32x16_bf16 v[32:47], v[64:67], v[68:71], v[32:47]
    v_mfma_f32_32x32x16_bf16 v[48:63], v[64:67], v[72:75], v[48:63]
    ds_read_b64 v[64:65], v19 offset:1056
    ds_read_b64 v[66:67], v19 offset:1064
    ds_read_b128 v[68:71], v20 offset:1200
    ds_read_b128 v[72:75], v20 offset:3760
    s_waitcnt lgkmcnt(12)
    v_mfma_f32_32x32x16_bf16 v[32:47], v[76:79], v[80:83], v[32:47]
    v_mfma_f32_32x32x16_bf16 v[48:63], v[76:79], v[84:87], v[48:63]
    ds_read_b64 v[76:77], v19 offset:1120
    ds_read_b64 v[78:79], v19 offset:1128
    ds_read_b128 v[80:83], v20 offset:1120
    ds_read_b128 v[84:87], v20 offset:3680
    s_waitcnt lgkmcnt(12)
    v_mfma_f32_32x32x16_bf16 v[32:47], v[88:91], v[92:95], v[32:47]
    v_mfma_f32_32x32x16_bf16 v[48:63], v[88:91], v[96:99], v[48:63]
    ds_read_b64 v[88:89], v19 offset:1184
    ds_read_b64 v[90:91], v19 offset:1192
    ds_read_b128 v[92:95], v20 offset:1040
    ds_read_b128 v[96:99], v20 offset:3600
    s_waitcnt lgkmcnt(12)
    v_mfma_f32_32x32x16_bf16 v[32:47], v[100:103], v[104:107], v[32:47]
    v_mfma_f32_32x32x16_bf16 v[48:63], v[100:103], v[108:111], v[48:63]
    ds_read_b64 v[100:101], v19 offset:1248
    ds_read_b64 v[102:103], v19 offset:1256
    ds_read_b128 v[104:107], v20 offset:960
    ds_read_b128 v[108:111], v20 offset:3520
    s_waitcnt lgkmcnt(12)
    v_mfma_f32_32x32x16_bf16 v[32:47], v[64:67], v[68:71], v[32:47]
    v_mfma_f32_32x32x16_bf16 v[48:63], v[64:67], v[72:75], v[48:63]
    ds_read_b64 v[64:65], v19 offset:1312
    ds_read_b64 v[66:67], v19 offset:1320
    ds_read_b128 v[68:71], v20 offset:880
    ds_read_b128 v[72:75], v20 offset:3440
    s_waitcnt lgkmcnt(12)
    v_mfma_f32_32x32x16_bf16 v[32:47], v[76:79], v[80:83], v[32:47]
    v_mfma_f32_32x32x16_bf16 v[48:63], v[76:79], v[84:87], v[48:63]
    ds_read_b64 v[76:77], v19 offset:1376
    ds_read_b64 v[78:79], v19 offset:1384
    ds_read_b128 v[80:83], v20 offset:800
    ds_read_b128 v[84:87], v20 offset:3360
    s_waitcnt lgkmcnt(12)
    v_mfma_f32_32x32x16_bf16 v[32:47], v[88:91], v[92:95], v[32:47]
    v_mfma_f32_32x32x16_bf16 v[48:63], v[88:91], v[96:99], v[48:63]
    ds_read_b64 v[88:89], v19 offset:1440
    ds_read_b64 v[90:91], v19 offset:1448
    ds_read_b128 v[92:95], v20 offset:720
    ds_read_b128 v[96:99], v20 offset:3280
    s_waitcnt lgkmcnt(12)
    v_mfma_f32_32x32x16_bf16 v[32:47], v[100:103], v[104:107], v[32:47]
    v_mfma_f32_32x32x16_bf16 v[48:63], v[100:103], v[108:111], v[48:63]
    ds_read_b64 v[100:101], v19 offset:1504
    ds_read_b64 v[102:103], v19 offset:1512
    ds_read_b128 v[104:107], v20 offset:640
    ds_read_b128 v[108:111], v20 offset:3200
    s_waitcnt lgkmcnt(12)
    v_mfma_f32_32x32x16_bf16 v[32:47], v[64:67], v[68:71], v[32:47]
    v_mfma_f32_32x32x16_bf16 v[48:63], v[64:67], v[72:75], v[48:63]
    ds_read_b64 v[64:65], v19 offset:1568
    ds_read_b64 v[66:67], v19 offset:1576
    ds_read_b128 v[68:71], v20 offset:560
    ds_read_b128 v[72:75], v20 offset:3120
    s_waitcnt lgkmcnt(12)
    v_mfma_f32_32x32x16_bf16 v[32:47], v[76:79], v[80:83], v[32:47]
    v_mfma_f32_32x32x16_bf16 v[48:63], v[76:79], v[84:87], v[48:63]
    ds_read_b64 v[76:77], v19 offset:1632
    ds_read_b64 v[78:79], v19 offset:1640
    ds_read_b128 v[80:83], v20 offset:480
    ds_read_b128 v[84:87], v20 offset:3040
    s_waitcnt lgkmcnt(12)
    v_mfma_f32_32x32x16_bf16 v[32:47], v[88:91], v[92:95], v[32:47]
    v_mfma_f32_32x32x16_bf16 v[48:63], v[88:91], v[96:99], v[48:63]
    ds_read_b64 v[88:89], v19 offset:1696
    ds_read_b64 v[90:91], v19 offset:1704
    ds_read_b128 v[92:95], v20 offset:400
    ds_read_b128 v[96:99], v20 offset:2960
    s_waitcnt lgkmcnt(12)
    v_mfma_f32_32x32x16_bf16 v[32:47], v[100:103], v[104:107], v[32:47]
    v_mfma_f32_32x32x16_bf16 v[48:63], v[100:103], v[108:111], v[48:63]
    ds_read_b64 v[100:101], v19 offset:1760
    ds_read_b64 v[102:103], v19 offset:1768
    ds_read_b128 v[104:107], v20 offset:320
    ds_read_b128 v[108:111], v20 offset:2880
    s_waitcnt lgkmcnt(12)
    v_mfma_f32_32x32x16_bf16 v[32:47], v[64:67], v[68:71], v[32:47]
    v_mfma_f32_32x32x16_bf16 v[48:63], v[64:67], v[72:75], v[48:63]
    ds_read_b64 v[64:65], v19 offset:1824
    ds_read_b64 v[66:67], v19 offset:1832
    ds_read_b128 v[68:71], v20 offset:240
    ds_read_b128 v[72:75], v20 offset:2800
    s_waitcnt lgkmcnt(12)
    v_mfma_f32_32x32x16_bf16 v[32:47], v[76:79], v[80:83], v[32:47]
    v_mfma_f32_32x32x16_bf16 v[48:63], v[76:79], v[84:87], v[48:63]
    ds_read_b64 v[76:77], v19 offset:1888
    ds_read_b64 v[78:79], v19 offset:1896
    ds_read_b128 v[80:83], v20 offset:160
    ds_read_b128 v[84:87], v20 offset:2720
    s_waitcnt lgkmcnt(12)
    v_mfma_f32_32x32x16_bf16 v[32:47], v[88:91], v[92:95], v[32:47]
    v_mfma_f32_32x32x16_bf16 v[48:63], v[88:91], v[96:99], v[48:63]
    ds_read_b64 v[88:89], v19 offset:1952
    ds_read_b64 v[90:91], v19 offset:1960
    ds_read_b128 v[92:95], v20 offset:80
    ds_read_b128 v[96:99], v20 offset:2640
    s_waitcnt lgkmcnt(12)
    v_mfma_f32_32x32x16_bf16 v[32:47], v[100:103], v[104:107], v[32:47]
    v_mfma_f32_32x32x16_bf16 v[48:63], v[100:103], v[108:111], v[48:63]
    ds_read_b64 v[100:101], v19 offset:2016
    ds_read_b64 v[102:103], v19 offset:2024
    ds_read_b128 v[104:107], v20 offset:0
    ds_read_b128 v[108:111], v20 offset:2560
    s_waitcnt lgkmcnt(12)
    v_mfma_f32_32x32x16_bf16 v[32:47], v[64:67], v[68:71], v[32:47]
    v_mfma_f32_32x32x16_bf16 v[48:63], v[64:67], v[72:75], v[48:63]
    ds_read_b64 v[64:65], v19 offset:2080
    ds_read_b64 v[66:67], v19 offset:2088
    ds_read_b128 v[72:75], v20 offset:2480
    s_waitcnt lgkmcnt(11)
    v_mfma_f32_32x32x16_bf16 v[32:47], v[76:79], v[80:83], v[32:47]
    v_mfma_f32_32x32x16_bf16 v[48:63], v[76:79], v[84:87], v[48:63]
    ds_read_b64 v[76:77], v19 offset:2144
    ds_read_b64 v[78:79], v19 offset:2152
    ds_read_b128 v[84:87], v20 offset:2400
    s_waitcnt lgkmcnt(10)
    v_mfma_f32_32x32x16_bf16 v[32:47], v[88:91], v[92:95], v[32:47]
    v_mfma_f32_32x32x16_bf16 v[48:63], v[88:91], v[96:99], v[48:63]
    ds_read_b64 v[88:89], v19 offset:2208
    ds_read_b64 v[90:91], v19 offset:2216
    ds_read_b128 v[96:99], v20 offset:2320
    s_waitcnt lgkmcnt(9)
    v_mfma_f32_32x32x16_bf16 v[32:47], v[100:103], v[104:107], v[32:47]
    v_mfma_f32_32x32x16_bf16 v[48:63], v[100:103], v[108:111], v[48:63]
    ds_read_b64 v[100:101], v19 offset:2272
    ds_read_b64 v[102:103], v19 offset:2280
    ds_read_b128 v[108:111], v20 offset:2240
    s_waitcnt lgkmcnt(9)
    v_mfma_f32_32x32x16_bf16 v[48:63], v[64:67], v[72:75], v[48:63]
    ds_read_b64 v[64:65], v19 offset:2336
    ds_read_b64 v[66:67], v19 offset:2344
    ds_read_b128 v[72:75], v20 offset:2160
    s_waitcnt lgkmcnt(9)
    v_mfma_f32_32x32x16_bf16 v[48:63], v[76:79], v[84:87], v[48:63]
    ds_read_b64 v[76:77], v19 offset:2400
    ds_read_b64 v[78:79], v19 offset:2408
    ds_read_b128 v[84:87], v20 offset:2080
    s_waitcnt lgkmcnt(9)
    v_mfma_f32_32x32x16_bf16 v[48:63], v[88:91], v[96:99], v[48:63]
    ds_read_b64 v[88:89], v19 offset:2464
    ds_read_b64 v[90:91], v19 offset:2472
    ds_read_b128 v[96:99], v20 offset:2000
    s_waitcnt lgkmcnt(9)
    v_mfma_f32_32x32x16_bf16 v[48:63], v[100:103], v[108:111], v[48:63]
    ds_read_b64 v[100:101], v19 offset:2528
    ds_read_b64 v[102:103], v19 offset:2536
    ds_read_b128 v[108:111], v20 offset:1920
    s_waitcnt lgkmcnt(9)
    v_mfma_f32_32x32x16_bf16 v[48:63], v[64:67], v[72:75], v[48:63]
    ds_read_b64 v[64:65], v19 offset:2592
    ds_read_b64 v[66:67], v19 offset:2600
    ds_read_b128 v[72:75], v20 offset:1840
    s_waitcnt lgkmcnt(9)
    v_mfma_f32_32x32x16_bf16 v[48:63], v[76:79], v[84:87], v[48:63]
    ds_read_b64 v[76:77], v19 offset:2656
    ds_read_b64 v[78:79], v19 offset:2664
    ds_read_b128 v[84:87], v20 offset:1760
    s_waitcnt lgkmcnt(9)
    v_mfma_f32_32x32x16_bf16 v[48:63], v[88:91], v[96:99], v[48:63]
    ds_read_b64 v[88:89], v19 offset:2720
    ds_read_b64 v[90:91], v19 offset:2728
    ds_read_b128 v[96:99], v20 offset:1680
    s_waitcnt lgkmcnt(9)
    v_mfma_f32_32x32x16_bf16 v[48:63], v[100:103], v[108:111], v[48:63]
    ds_read_b64 v[100:101], v19 offset:2784
    ds_read_b64 v[102:103], v19 offset:2792
    ds_read_b128 v[108:111], v20 offset:1600
    s_waitcnt lgkmcnt(9)
    v_mfma_f32_32x32x16_bf16 v[48:63], v[64:67], v[72:75], v[48:63]
    ds_read_b64 v[64:65], v19 offset:2848
    ds_read_b64 v[66:67], v19 offset:2856
    ds_read_b128 v[72:75], v20 offset:1520
    s_waitcnt lgkmcnt(9)
    v_mfma_f32_32x32x16_bf16 v[48:63], v[76:79], v[84:87], v[48:63]
    ds_read_b64 v[76:77], v19 offset:2912
    ds_read_b64 v[78:79], v19 offset:2920
    ds_read_b128 v[84:87], v20 offset:1440
    s_waitcnt lgkmcnt(9)
    v_mfma_f32_32x32x16_bf16 v[48:63], v[88:91], v[96:99], v[48:63]
    ds_read_b64 v[88:89], v19 offset:2976
    ds_read_b64 v[90:91], v19 offset:2984
    ds_read_b128 v[96:99], v20 offset:1360
    s_waitcnt lgkmcnt(9)
    v_mfma_f32_32x32x16_bf16 v[48:63], v[100:103], v[108:111], v[48:63]
    ds_read_b64 v[100:101], v19 offset:3040
    ds_read_b64 v[102:103], v19 offset:3048
    ds_read_b128 v[108:111], v20 offset:1280
    s_waitcnt lgkmcnt(9)
    v_mfma_f32_32x32x16_bf16 v[48:63], v[64:67], v[72:75], v[48:63]
    ds_read_b64 v[64:65], v19 offset:3104
    ds_read_b64 v[66:67], v19 offset:3112
    ds_read_b128 v[72:75], v20 offset:1200
    s_waitcnt lgkmcnt(9)
    v_mfma_f32_32x32x16_bf16 v[48:63], v[76:79], v[84:87], v[48:63]
    ds_read_b64 v[76:77], v19 offset:3168
    ds_read_b64 v[78:79], v19 offset:3176
    ds_read_b128 v[84:87], v20 offset:1120
    s_waitcnt lgkmcnt(9)
    v_mfma_f32_32x32x16_bf16 v[48:63], v[88:91], v[96:99], v[48:63]
    ds_read_b64 v[88:89], v19 offset:3232
    ds_read_b64 v[90:91], v19 offset:3240
    ds_read_b128 v[96:99], v20 offset:1040
    s_waitcnt lgkmcnt(9)
    v_mfma_f32_32x32x16_bf16 v[48:63], v[100:103], v[108:111], v[48:63]
    ds_read_b64 v[100:101], v19 offset:3296
    ds_read_b64 v[102:103], v19 offset:3304
    ds_read_b128 v[108:111], v20 offset:960
    s_waitcnt lgkmcnt(9)
    v_mfma_f32_32x32x16_bf16 v[48:63], v[64:67], v[72:75], v[48:63]
    ds_read_b64 v[64:65], v19 offset:3360
    ds_read_b64 v[66:67], v19 offset:3368
    ds_read_b128 v[72:75], v20 offset:880
    s_waitcnt lgkmcnt(9)
    v_mfma_f32_32x32x16_bf16 v[48:63], v[76:79], v[84:87], v[48:63]
    ds_read_b64 v[76:77], v19 offset:3424
    ds_read_b64 v[78:79], v19 offset:3432
    ds_read_b128 v[84:87], v20 offset:800
    s_waitcnt lgkmcnt(9)
    v_mfma_f32_32x32x16_bf16 v[48:63], v[88:91], v[96:99], v[48:63]
    ds_read_b64 v[88:89], v19 offset:3488
    ds_read_b64 v[90:91], v19 offset:3496
    ds_read_b128 v[96:99], v20 offset:720
    s_waitcnt lgkmcnt(9)
    v_mfma_f32_32x32x16_bf16 v[48:63], v[100:103], v[108:111], v[48:63]
    ds_read_b64 v[100:101], v19 offset:3552
    ds_read_b64 v[102:103], v19 offset:3560
    ds_read_b128 v[108:111], v20 offset:640
    s_waitcnt lgkmcnt(9)
    v_mfma_f32_32x32x16_bf16 v[48:63], v[64:67], v[72:75], v[48:63]
    ds_read_b64 v[64:65], v19 offset:3616
    ds_read_b64 v[66:67], v19 offset:3624
    ds_read_b128 v[72:75], v20 offset:560
    s_waitcnt lgkmcnt(9)
    v_mfma_f32_32x32x16_bf16 v[48:63], v[76:79], v[84:87], v[48:63]
    ds_read_b64 v[76:77], v19 offset:3680
    ds_read_b64 v[78:79], v19 offset:3688
    ds_read_b128 v[84:87], v20 offset:480
    s_waitcnt lgkmcnt(9)
    v_mfma_f32_32x32x16_bf16 v[48:63], v[88:91], v[96:99], v[48:63]
    ds_read_b64 v[88:89], v19 offset:3744
    ds_read_b64 v[90:91], v19 offset:3752
    ds_read_b128 v[96:99], v20 offset:400
    s_waitcnt lgkmcnt(9)
    v_mfma_f32_32x32x16_bf16 v[48:63], v[100:103], v[108:111], v[48:63]
    ds_read_b64 v[100:101], v19 offset:3808
    ds_read_b64 v[102:103], v19 offset:3816
    ds_read_b128 v[108:111], v20 offset:320
    s_waitcnt lgkmcnt(9)
    v_mfma_f32_32x32x16_bf16 v[48:63], v[64:67], v[72:75], v[48:63]
    ds_read_b64 v[64:65], v19 offset:3872
    ds_read_b64 v[66:67], v19 offset:3880
    ds_read_b128 v[72:75], v20 offset:240
    s_waitcnt lgkmcnt(9)
    v_mfma_f32_32x32x16_bf16 v[48:63], v[76:79], v[84:87], v[48:63]
    ds_read_b64 v[76:77], v19 offset:3936
    ds_read_b64 v[78:79], v19 offset:3944
    ds_read_b128 v[84:87], v20 offset:160
    s_waitcnt lgkmcnt(9)
    v_mfma_f32_32x32x16_bf16 v[48:63], v[88:91], v[96:99], v[48:63]
    ds_read_b64 v[88:89], v19 offset:4000
    ds_read_b64 v[90:91], v19 offset:4008
    ds_read_b128 v[96:99], v20 offset:80
    s_waitcnt lgkmcnt(9)
    v_mfma_f32_32x32x16_bf16 v[48:63], v[100:103], v[108:111], v[48:63]
    ds_read_b64 v[100:101], v19 offset:4064
    ds_read_b64 v[102:103], v19 offset:4072
    ds_read_b128 v[108:111], v20 offset:0
    s_waitcnt lgkmcnt(9)
    v_mfma_f32_32x32x16_bf16 v[48:63], v[64:67], v[72:75], v[48:63]
    s_waitcnt lgkmcnt(6)
    v_mfma_f32_32x32x16_bf16 v[48:63], v[76:79], v[84:87], v[48:63]
    s_waitcnt lgkmcnt(3)
    v_mfma_f32_32x32x16_bf16 v[48:63], v[88:91], v[96:99], v[48:63]
    s_waitcnt lgkmcnt(0)
    v_mfma_f32_32x32x16_bf16 v[48:63], v[100:103], v[108:111], v[48:63]
    v_mul_u32_u24 v21, 80, v16
    v_lshlrev_b32 v22, 3, v17
    v_add_u32 v24, v21, v22
    v_sub_u32 v21, v21, v22
    v_add_u32 v21, 2568, v21
    s_mul_i32 s24, s27, 2560
    s_add_u32 s22, s48, s24
    v_add_u32 v21, s22, v21
    ds_read_b64 v[64:65], v21 offset:0
    ds_read_b64 v[66:67], v21 offset:16
    ds_read_b64 v[68:69], v21 offset:32
    ds_read_b64 v[70:71], v21 offset:48
    s_lshl_b32 s24, s27, 12
    s_add_u32 s22, s59, s24
    v_add_u32 v25, s22, v3
    s_xor_b32 s24, s24, 4096
    s_add_u32 s22, s59, s24
    v_add_u32 v26, s22, v3
    s_barrier
    s_cmp_eq_u32 s27, 0
    s_cbranch_scc1 L_k2_kernel_r1_noswap
    v_swap_b32 v32, v48
    v_swap_b32 v33, v49
    v_swap_b32 v34, v50
    v_swap_b32 v35, v51
    v_swap_b32 v36, v52
    v_swap_b32 v37, v53
    v_swap_b32 v38, v54
    v_swap_b32 v39, v55
    v_swap_b32 v40, v56
    v_swap_b32 v41, v57
    v_swap_b32 v42, v58
    v_swap_b32 v43, v59
    v_swap_b32 v44, v60
    v_swap_b32 v45, v61
    v_swap_b32 v46, v62
    v_swap_b32 v47, v63
L_k2_kernel_r1_noswap:
    ds_write_b128 v25, v[48:51] offset:0
    ds_write_b128 v25, v[52:55] offset:1024
    ds_write_b128 v25, v[56:59] offset:2048
    ds_write_b128 v25, v[60:63] offset:3072
    s_waitcnt lgkmcnt(0)
    s_barrier
    ds_read_b128 v[48:51], v26 offset:0
    ds_read_b128 v[52:55], v26 offset:1024
    ds_read_b128 v[56:59], v26 offset:2048
    ds_read_b128 v[60:63], v26 offset:3072
    s_waitcnt vmcnt(0)
    v_lshlrev_b32 v15, 16, v15
    s_mul_i32 s24, s27, 2560
    s_add_u32 s24, s24, s59
    s_add_u32 s24, s24, 8192
    v_add_u32 v24, s24, v24
    v_add_u32 v7, s24, v7
    s_waitcnt lgkmcnt(3)
    v_add_f32 v32, v32, v48
    v_and_b32 v26, 0xffff0000, v65
    v_mul_f32 v26, v26, v15
    v_cvt_pk_bf16_f32 v26, v26, v32
    v_lshlrev_b32 v25, 16, v26
    v_and_b32 v26, 0xffff0000, v26
    v_add_f32 v26, v26, v25
    v_add_f32 v33, v33, v49
    v_lshlrev_b32 v27, 16, v65
    v_mul_f32 v27, v27, v15
    v_cvt_pk_bf16_f32 v27, v27, v33
    v_lshlrev_b32 v25, 16, v27
    v_and_b32 v27, 0xffff0000, v27
    v_add_f32 v27, v27, v25
    v_add_f32 v34, v34, v50
    v_and_b32 v28, 0xffff0000, v64
    v_mul_f32 v28, v28, v15
    v_cvt_pk_bf16_f32 v28, v28, v34
    v_lshlrev_b32 v25, 16, v28
    v_and_b32 v28, 0xffff0000, v28
    v_add_f32 v28, v28, v25
    v_add_f32 v35, v35, v51
    v_lshlrev_b32 v29, 16, v64
    v_mul_f32 v29, v29, v15
    v_cvt_pk_bf16_f32 v29, v29, v35
    v_lshlrev_b32 v25, 16, v29
    v_and_b32 v29, 0xffff0000, v29
    v_add_f32 v29, v29, v25
    v_cvt_pk_bf16_f32 v30, v26, v27
    v_cvt_pk_bf16_f32 v31, v28, v29
    ds_write_b64 v24, v[30:31] offset:0
    s_waitcnt lgkmcnt(2)
    v_add_f32 v36, v36, v52
    v_and_b32 v26, 0xffff0000, v67
    v_mul_f32 v26, v26, v15
    v_cvt_pk_bf16_f32 v26, v26, v36
    v_lshlrev_b32 v25, 16, v26
    v_and_b32 v26, 0xffff0000, v26
    v_add_f32 v26, v26, v25
    v_add_f32 v37, v37, v53
    v_lshlrev_b32 v27, 16, v67
    v_mul_f32 v27, v27, v15
    v_cvt_pk_bf16_f32 v27, v27, v37
    v_lshlrev_b32 v25, 16, v27
    v_and_b32 v27, 0xffff0000, v27
    v_add_f32 v27, v27, v25
    v_add_f32 v38, v38, v54
    v_and_b32 v28, 0xffff0000, v66
    v_mul_f32 v28, v28, v15
    v_cvt_pk_bf16_f32 v28, v28, v38
    v_lshlrev_b32 v25, 16, v28
    v_and_b32 v28, 0xffff0000, v28
    v_add_f32 v28, v28, v25
    v_add_f32 v39, v39, v55
    v_lshlrev_b32 v29, 16, v66
    v_mul_f32 v29, v29, v15
    v_cvt_pk_bf16_f32 v29, v29, v39
    v_lshlrev_b32 v25, 16, v29
    v_and_b32 v29, 0xffff0000, v29
    v_add_f32 v29, v29, v25
    v_cvt_pk_bf16_f32 v30, v26, v27
    v_cvt_pk_bf16_f32 v31, v28, v29
    ds_write_b64 v24, v[30:31] offset:16
    s_waitcnt lgkmcnt(1)
    v_add_f32 v40, v40, v56
    v_and_b32 v26, 0xffff0000, v69
    v_mul_f32 v26, v26, v15
    v_cvt_pk_bf16_f32 v26, v26, v40
    v_lshlrev_b32 v25, 16, v26
    v_and_b32 v26, 0xffff0000, v26
    v_add_f32 v26, v26, v25
    v_add_f32 v41, v41, v57
    v_lshlrev_b32 v27, 16, v69
    v_mul_f32 v27, v27, v15
    v_cvt_pk_bf16_f32 v27, v27, v41
    v_lshlrev_b32 v25, 16, v27
    v_and_b32 v27, 0xffff0000, v27
    v_add_f32 v27, v27, v25
    v_add_f32 v42, v42, v58
    v_and_b32 v28, 0xffff0000, v68
    v_mul_f32 v28, v28, v15
    v_cvt_pk_bf16_f32 v28, v28, v42
    v_lshlrev_b32 v25, 16, v28
    v_and_b32 v28, 0xffff0000, v28
    v_add_f32 v28, v28, v25
    v_add_f32 v43, v43, v59
    v_lshlrev_b32 v29, 16, v68
    v_mul_f32 v29, v29, v15
    v_cvt_pk_bf16_f32 v29, v29, v43
    v_lshlrev_b32 v25, 16, v29
    v_and_b32 v29, 0xffff0000, v29
    v_add_f32 v29, v29, v25
    v_cvt_pk_bf16_f32 v30, v26, v27
    v_cvt_pk_bf16_f32 v31, v28, v29
    ds_write_b64 v24, v[30:31] offset:32
    s_waitcnt lgkmcnt(0)
    v_add_f32 v44, v44, v60
    v_and_b32 v26, 0xffff0000, v71
    v_mul_f32 v26, v26, v15
    v_cvt_pk_bf16_f32 v26, v26, v44
    v_lshlrev_b32 v25, 16, v26
    v_and_b32 v26, 0xffff0000, v26
    v_add_f32 v26, v26, v25
    v_add_f32 v45, v45, v61
    v_lshlrev_b32 v27, 16, v71
    v_mul_f32 v27, v27, v15
    v_cvt_pk_bf16_f32 v27, v27, v45
    v_lshlrev_b32 v25, 16, v27
    v_and_b32 v27, 0xffff0000, v27
    v_add_f32 v27, v27, v25
    v_add_f32 v46, v46, v62
    v_and_b32 v28, 0xffff0000, v70
    v_mul_f32 v28, v28, v15
    v_cvt_pk_bf16_f32 v28, v28, v46
    v_lshlrev_b32 v25, 16, v28
    v_and_b32 v28, 0xffff0000, v28
    v_add_f32 v28, v28, v25
    v_add_f32 v47, v47, v63
    v_lshlrev_b32 v29, 16, v70
    v_mul_f32 v29, v29, v15
    v_cvt_pk_bf16_f32 v29, v29, v47
    v_lshlrev_b32 v25, 16, v29
    v_and_b32 v29, 0xffff0000, v29
    v_add_f32 v29, v29, v25
    v_cvt_pk_bf16_f32 v30, v26, v27
    v_cvt_pk_bf16_f32 v31, v28, v29
    ds_write_b64 v24, v[30:31] offset:48
    ds_read_b128 v[112:115], v7 offset:0
    ds_read_b128 v[116:119], v7 offset:1280
    s_add_u32 s50, s49, 58720256
    s_waitcnt lgkmcnt(1)
    buffer_store_dwordx4 v[112:115], v3, s[44:47], s50 offen offset:0 sc1
    s_waitcnt lgkmcnt(0)
    buffer_store_dwordx4 v[116:119], v3, s[44:47], s50 offen offset:1024 sc1
    s_endpgm
.globl k3_kernel
.p2align 8
.type k3_kernel,@function
k3_kernel:
    s_mov_b32 s94, s2
    s_cmp_lt_u32 s2, 256
    s_cbranch_scc1 L_k3_kernel_r0
    s_sub_u32 s2, s2, 256
    s_cmp_lt_u32 s2, 256
    s_cbranch_scc1 L_k3_kernel_r1
    s_sub_u32 s2, s2, 256
    s_endpgm
.p2align 6
L_k3_kernel_r0:
    s_mov_b32 s57, 75497472
    s_load_dwordx2 s[4:5], s[0:1], 80
    s_load_dwordx2 s[28:29], s[0:1], 96
    s_and_b32 s16, s2, 7
    s_lshr_b32 s17, s2, 3
    s_lshr_b32 s18, s17, 2
    s_lshl_b32 s18, s18, 3
    s_add_u32 s16, s16, s18
    s_lshl_b32 s16, s16, 2
    s_and_b32 s17, s17, 3
    s_add_u32 s16, s16, s17
    s_cmp_lt_u32 s2, 256
    s_cselect_b32 s2, s16, s2
    s_mov_b32 s20, 0x3f6c835e
    s_mov_b32 s21, 0xbec3ef15
    s_mov_b32 s22, 0x3f3504f3
    s_mov_b32 s23, 0xbf3504f3
    s_mov_b32 s24, 0x3ec3ef15
    s_mov_b32 s25, 0xbf6c835e
    v_lshrrev_b32 v5, 6, v0
    s_nop 0
    v_readfirstlane_b32 s30, v5
    v_and_b32 v6, 63, v0
    v_and_b32 v1, 1, v0
    v_lshrrev_b32 v2, 1, v0
    v_lshlrev_b32 v3, 13, v2
    v_lshl_add_u32 v3, v1, 4, v3
    v_mul_u32_u24 v4, 48, v2
    v_lshl_add_u32 v4, v1, 4, v4
    s_lshl_b32 s31, s2, 5
    s_add_u32 s31, s31, 16777216
    s_waitcnt lgkmcnt(0)
    s_mov_b32 s8, s4
    s_mov_b32 s9, s5
    s_mov_b32 s10, 8388608
    s_mov_b32 s11, 0x00020000
    s_mov_b32 s32, s28
    s_mov_b32 s33, s29
    s_mov_b32 s34, 268435456
    s_mov_b32 s35, 0x00020000
    buffer_load_dwordx4 v[72:75], v3, s[32:35], s31 offen
    s_add_u32 s31, s31, 1048576
    buffer_load_dwordx4 v[76:79], v3, s[32:35], s31 offen
    s_add_u32 s31, s31, 1048576
    buffer_load_dwordx4 v[80:83], v3, s[32:35], s31 offen
    s_add_u32 s31, s31, 1048576
    buffer_load_dwordx4 v[84:87], v3, s[32:35], s31 offen
    v_cvt_f32_u32 v10, v6
    v_mul_f32 v11, 0x3b000000, v10
    v_cos_f32 v42, v11
    v_sin_f32_e64 v43, -v11
    v_mul_f32 v45, 0x40000000, v11
    v_cos_f32 v44, v45
    v_sin_f32_e64 v45, -v45
    v_mul_f32 v47, 0x40400000, v11
    v_cos_f32 v46, v47
    v_sin_f32_e64 v47, -v47
    v_mul_f32 v49, 0x40800000, v11
    v_cos_f32 v48, v49
    v_sin_f32_e64 v49, -v49
    v_mul_f32 v51, 0x40a00000, v11
    v_cos_f32 v50, v51
    v_sin_f32_e64 v51, -v51
    v_mul_f32 v53, 0x40c00000, v11
    v_cos_f32 v52, v53
    v_sin_f32_e64 v53, -v53
    v_mul_f32 v55, 0x40e00000, v11
    v_cos_f32 v54, v55
    v_sin_f32_e64 v55, -v55
    v_and_b32 v12, 7, v6
    v_lshrrev_b32 v13, 3, v6
    v_cvt_f32_u32 v14, v12
    v_mul_f32 v15, 0x3c800000, v14
    v_cos_f32 v58, v15
    v_sin_f32_e64 v59, -v15
    v_mul_f32 v61, 0x40000000, v15
    v_cos_f32 v60, v61
    v_sin_f32_e64 v61, -v61
    v_mul_f32 v63, 0x40400000, v15
    v_cos_f32 v62, v63
    v_sin_f32_e64 v63, -v63
    v_mul_f32 v65, 0x40800000, v15
    v_cos_f32 v64, v65
    v_sin_f32_e64 v65, -v65
    v_mul_f32 v67, 0x40a00000, v15
    v_cos_f32 v66, v67
    v_sin_f32_e64 v67, -v67
    v_mul_f32 v69, 0x40c00000, v15
    v_cos_f32 v68, v69
    v_sin_f32_e64 v69, -v69
    v_mul_f32 v71, 0x40e00000, v15
    v_cos_f32 v70, v71
    v_sin_f32_e64 v71, -v71
    s_mul_i32 s40, s30, 10464
    s_add_u32 s41, s40, 5232
    v_lshlrev_b32 v16, 3, v6
    v_mul_u32_u24 v17, 72, v13
    v_add_u32 v17, v17, v12
    v_lshlrev_b32 v17, 3, v17
    v_mul_u32_u24 v18, 10, v13
    v_add_u32 v18, v18, v12
    v_lshlrev_b32 v18, 3, v18
    v_mul_u32_u24 v19, 80, v6
    v_add_u32 v22, s40, v16
    v_add_u32 v23, s40, v17
    v_add_u32 v24, s40, v18
    v_add_u32 v25, s40, v19
    v_add_u32 v26, s41, v16
    v_add_u32 v27, s41, v17
    v_add_u32 v28, s41, v18
    v_add_u32 v29, s41, v19
    v_mul_u32_u24 v30, 48, v6
    s_lshl_b32 s42, s30, 3
    v_add_u32 v30, s42, v30
    s_waitcnt vmcnt(3)
    ds_write_b128 v4, v[72:75] offset:0
    s_waitcnt vmcnt(2)
    ds_write_b128 v4, v[76:79] offset:6144
    s_waitcnt vmcnt(1)
    ds_write_b128 v4, v[80:83] offset:12288
    s_waitcnt vmcnt(0)
    ds_write_b128 v4, v[84:87] offset:18432
    s_waitcnt lgkmcnt(0)
    s_barrier
    ds_read_b64 v[72:73], v30 offset:0
    ds_read_b64 v[74:75], v30 offset:3072
    ds_read_b64 v[76:77], v30 offset:6144
    ds_read_b64 v[78:79], v30 offset:9216
    ds_read_b64 v[80:81], v30 offset:12288
    ds_read_b64 v[82:83], v30 offset:15360
    ds_read_b64 v[84:85], v30 offset:18432
    ds_read_b64 v[86:87], v30 offset:21504
    s_waitcnt lgkmcnt(0)
    s_barrier
    v_lshlrev_b32 v104, 16, v72
    v_and_b32 v105, 0xffff0000, v72
    v_lshlrev_b32 v106, 16, v74
    v_and_b32 v107, 0xffff0000, v74
    v_lshlrev_b32 v108, 16, v76
    v_and_b32 v109, 0xffff0000, v76
    v_lshlrev_b32 v110, 16, v78
    v_and_b32 v111, 0xffff0000, v78
    v_lshlrev_b32 v112, 16, v80
    v_and_b32 v113, 0xffff0000, v80
    v_lshlrev_b32 v114, 16, v82
    v_and_b32 v115, 0xffff0000, v82
    v_lshlrev_b32 v116, 16, v84
    v_and_b32 v117, 0xffff0000, v84
    v_lshlrev_b32 v118, 16, v86
    v_and_b32 v119, 0xffff0000, v86
    v_lshlrev_b32 v120, 16, v73
    v_and_b32 v121, 0xffff0000, v73
    v_lshlrev_b32 v122, 16, v75
    v_and_b32 v123, 0xffff0000, v75
    v_lshlrev_b32 v124, 16, v77
    v_and_b32 v125, 0xffff0000, v77
    v_lshlrev_b32 v126, 16, v79
    v_and_b32 v127, 0xffff0000, v79
    v_lshlrev_b32 v128, 16, v81
    v_and_b32 v129, 0xffff0000, v81
    v_lshlrev_b32 v130, 16, v83
    v_and_b32 v131, 0xffff0000, v83
    v_lshlrev_b32 v132, 16, v85
    v_and_b32 v133, 0xffff0000, v85
    v_lshlrev_b32 v134, 16, v87
    v_and_b32 v135, 0xffff0000, v87
    v_pk_add_f32 v[136:137], v[104:105], v[112:113] neg_lo:[0,1] neg_hi:[0,1]
    v_pk_add_f32 v[104:105], v[104:105], v[112:113]
    v_pk_add_f32 v[138:139], v[106:107], v[114:115] neg_lo:[0,1] neg_hi:[0,1]
    v_pk_add_f32 v[106:107], v[106:107], v[114:115]
    v_pk_mul_f32 v[140:141], v[138:139], s[22:23] op_sel:[0,0] op_sel_hi:[1,0]
    v_pk_fma_f32 v[138:139], v[138:139], s[22:23], v[140:141] op_sel:[1,1,0] op_sel_hi:[0,1,1] neg_hi:[0,1,0]
    v_pk_add_f32 v[142:143], v[108:109], v[116:117] neg_lo:[0,1] neg_hi:[0,1]
    v_pk_add_f32 v[108:109], v[108:109], v[116:117]
    v_pk_add_f32 v[144:145], v[110:111], v[118:119] neg_lo:[0,1] neg_hi:[0,1]
    v_pk_add_f32 v[110:111], v[110:111], v[118:119]
    v_pk_mul_f32 v[146:147], v[144:145], s[22:23] op_sel:[0,0] op_sel_hi:[1,0]
    v_pk_fma_f32 v[144:145], v[144:145], s[22:23], v[146:147] op_sel:[1,1,0] op_sel_hi:[0,1,1] neg_hi:[0,1,0]
    v_pk_add_f32 v[148:149], v[104:105], v[108:109] neg_lo:[0,1] neg_hi:[0,1]
    v_pk_add_f32 v[104:105], v[104:105], v[108:109]
    v_pk_add_f32 v[108:109], v[106:107], v[110:111] neg_lo:[0,1] neg_hi:[0,1]
    v_pk_add_f32 v[106:107], v[106:107], v[110:111]
    v_pk_add_f32 v[110:111], v[104:105], v[106:107] neg_lo:[0,1] neg_hi:[0,1]
    v_pk_add_f32 v[104:105], v[104:105], v[106:107]
    v_pk_add_f32 v[106:107], v[148:149], v[108:109] op_sel:[0,1] op_sel_hi:[1,0] neg_lo:[0,1]
    v_pk_add_f32 v[148:149], v[148:149], v[108:109] op_sel:[0,1] op_sel_hi:[1,0] neg_hi:[0,1]
    v_pk_add_f32 v[150:151], v[136:137], v[142:143] op_sel:[0,1] op_sel_hi:[1,0] neg_hi:[0,1]
    v_pk_add_f32 v[136:137], v[136:137], v[142:143] op_sel:[0,1] op_sel_hi:[1,0] neg_lo:[0,1]
    v_pk_add_f32 v[142:143], v[138:139], v[144:145] op_sel:[0,1] op_sel_hi:[1,0] neg_hi:[0,1]
    v_pk_add_f32 v[138:139], v[138:139], v[144:145] op_sel:[0,1] op_sel_hi:[1,0] neg_lo:[0,1]
    v_pk_add_f32 v[144:145], v[136:137], v[138:139] neg_lo:[0,1] neg_hi:[0,1]
    v_pk_add_f32 v[136:137], v[136:137], v[138:139]
    v_pk_add_f32 v[138:139], v[150:151], v[142:143] op_sel:[0,1] op_sel_hi:[1,0] neg_lo:[0,1]
    v_pk_add_f32 v[150:151], v[150:151], v[142:143] op_sel:[0,1] op_sel_hi:[1,0] neg_hi:[0,1]
    ds_write_b64 v25, v[104:105] offset:0
    ds_write_b64 v25, v[136:137] offset:8
    ds_write_b64 v25, v[106:107] offset:16
    ds_write_b64 v25, v[138:139] offset:24
    ds_write_b64 v25, v[110:111] offset:32
    ds_write_b64 v25, v[144:145] offset:40
    ds_write_b64 v25, v[148:149] offset:48
    ds_write_b64 v25, v[150:151] offset:56
    v_pk_add_f32 v[112:113], v[120:121], v[128:129] neg_lo:[0,1] neg_hi:[0,1]
    v_pk_add_f32 v[120:121], v[120:121], v[128:129]
    v_pk_add_f32 v[114:115], v[122:123], v[130:131] neg_lo:[0,1] neg_hi:[0,1]
    v_pk_add_f32 v[122:123], v[122:123], v[130:131]
    v_pk_mul_f32 v[140:141], v[114:115], s[22:23] op_sel:[0,0] op_sel_hi:[1,0]
    v_pk_fma_f32 v[114:115], v[114:115], s[22:23], v[140:141] op_sel:[1,1,0] op_sel_hi:[0,1,1] neg_hi:[0,1,0]
    v_pk_add_f32 v[116:117], v[124:125], v[132:133] neg_lo:[0,1] neg_hi:[0,1]
    v_pk_add_f32 v[124:125], v[124:125], v[132:133]
    v_pk_add_f32 v[118:119], v[126:127], v[134:135] neg_lo:[0,1] neg_hi:[0,1]
    v_pk_add_f32 v[126:127], v[126:127], v[134:135]
    v_pk_mul_f32 v[146:147], v[118:119], s[22:23] op_sel:[0,0] op_sel_hi:[1,0]
    v_pk_fma_f32 v[118:119], v[118:119], s[22:23], v[146:147] op_sel:[1,1,0] op_sel_hi:[0,1,1] neg_hi:[0,1,0]
    v_pk_add_f32 v[108:109], v[120:121], v[124:125] neg_lo:[0,1] neg_hi:[0,1]
    v_pk_add_f32 v[120:121], v[120:121], v[124:125]
    v_pk_add_f32 v[124:125], v[122:123], v[126:127] neg_lo:[0,1] neg_hi:[0,1]
    v_pk_add_f32 v[122:123], v[122:123], v[126:127]
    v_pk_add_f32 v[126:127], v[120:121], v[122:123] neg_lo:[0,1] neg_hi:[0,1]
    v_pk_add_f32 v[120:121], v[120:121], v[122:123]
    v_pk_add_f32 v[122:123], v[108:109], v[124:125] op_sel:[0,1] op_sel_hi:[1,0] neg_lo:[0,1]
    v_pk_add_f32 v[108:109], v[108:109], v[124:125] op_sel:[0,1] op_sel_hi:[1,0] neg_hi:[0,1]
    v_pk_add_f32 v[142:143], v[112:113], v[116:117] op_sel:[0,1] op_sel_hi:[1,0] neg_hi:[0,1]
    v_pk_add_f32 v[112:113], v[112:113], v[116:117] op_sel:[0,1] op_sel_hi:[1,0] neg_lo:[0,1]
    v_pk_add_f32 v[116:117], v[114:115], v[118:119] op_sel:[0,1] op_sel_hi:[1,0] neg_hi:[0,1]
    v_pk_add_f32 v[114:115], v[114:115], v[118:119] op_sel:[0,1] op_sel_hi:[1,0] neg_lo:[0,1]
    v_pk_add_f32 v[118:119], v[112:113], v[114:115] neg_lo:[0,1] neg_hi:[0,1]
    v_pk_add_f32 v[112:113], v[112:113], v[114:115]
    v_pk_add_f32 v[114:115], v[142:143], v[116:117] op_sel:[0,1] op_sel_hi:[1,0] neg_lo:[0,1]
    v_pk_add_f32 v[142:143], v[142:143], v[116:117] op_sel:[0,1] op_sel_hi:[1,0] neg_hi:[0,1]
    ds_write_b64 v29, v[120:121] offset:0
    ds_write_b64 v29, v[112:113] offset:8
    ds_write_b64 v29, v[122:123] offset:16
    ds_write_b64 v29, v[114:115] offset:24
    ds_write_b64 v29, v[126:127] offset:32
    ds_write_b64 v29, v[118:119] offset:40
    ds_write_b64 v29, v[108:109] offset:48
    ds_write_b64 v29, v[142:143] offset:56
    ds_read_b64 v[104:105], v24 offset:0
    ds_read_b64 v[136:137], v24 offset:640
    ds_read_b64 v[106:107], v24 offset:1280
    ds_read_b64 v[138:139], v24 offset:1920
    ds_read_b64 v[110:111], v24 offset:2560
    ds_read_b64 v[144:145], v24 offset:3200
    ds_read_b64 v[148:149], v24 offset:3840
    ds_read_b64 v[150:151], v24 offset:4480
    ds_read_b64 v[128:129], v28 offset:0
    ds_read_b64 v[130:131], v28 offset:640
    ds_read_b64 v[140:141], v28 offset:1280
    ds_read_b64 v[132:133], v28 offset:1920
    ds_read_b64 v[134:135], v28 offset:2560
    ds_read_b64 v[146:147], v28 offset:3200
    ds_read_b64 v[124:125], v28 offset:3840
    ds_read_b64 v[116:117], v28 offset:4480
    s_waitcnt lgkmcnt(8)
    v_pk_mul_f32 v[120:121], v[136:137], v[58:59] op_sel:[0,0] op_sel_hi:[1,0]
    v_pk_fma_f32 v[136:137], v[136:137], v[58:59], v[120:121] op_sel:[1,1,0] op_sel_hi:[0,1,1] neg_hi:[0,1,0]
    v_pk_mul_f32 v[112:113], v[106:107], v[60:61] op_sel:[0,0] op_sel_hi:[1,0]
    v_pk_fma_f32 v[106:107], v[106:107], v[60:61], v[112:113] op_sel:[1,1,0] op_sel_hi:[0,1,1] neg_hi:[0,1,0]
    v_pk_mul_f32 v[122:123], v[138:139], v[62:63] op_sel:[0,0] op_sel_hi:[1,0]
    v_pk_fma_f32 v[138:139], v[138:139], v[62:63], v[122:123] op_sel:[1,1,0] op_sel_hi:[0,1,1] neg_hi:[0,1,0]
    v_pk_mul_f32 v[114:115], v[110:111], v[64:65] op_sel:[0,0] op_sel_hi:[1,0]
    v_pk_fma_f32 v[110:111], v[110:111], v[64:65], v[114:115] op_sel:[1,1,0] op_sel_hi:[0,1,1] neg_hi:[0,1,0]
    v_pk_mul_f32 v[126:127], v[144:145], v[66:67] op_sel:[0,0] op_sel_hi:[1,0]
    v_pk_fma_f32 v[144:145], v[144:145], v[66:67], v[126:127] op_sel:[1,1,0] op_sel_hi:[0,1,1] neg_hi:[0,1,0]
    v_pk_mul_f32 v[118:119], v[148:149], v[68:69] op_sel:[0,0] op_sel_hi:[1,0]
    v_pk_fma_f32 v[148:149], v[148:149], v[68:69], v[118:119] op_sel:[1,1,0] op_sel_hi:[0,1,1] neg_hi:[0,1,0]
    v_pk_mul_f32 v[108:109], v[150:151], v[70:71] op_sel:[0,0] op_sel_hi:[1,0]
    v_pk_fma_f32 v[150:151], v[150:151], v[70:71], v[108:109] op_sel:[1,1,0] op_sel_hi:[0,1,1] neg_hi:[0,1,0]
    v_pk_add_f32 v[142:143], v[104:105], v[110:111] neg_lo:[0,1] neg_hi:[0,1]
    v_pk_add_f32 v[104:105], v[104:105], v[110:111]
    v_pk_add_f32 v[120:121], v[136:137], v[144:145] neg_lo:[0,1] neg_hi:[0,1]
    v_pk_add_f32 v[136:137], v[136:137], v[144:145]
    v_pk_mul_f32 v[112:113], v[120:121], s[22:23] op_sel:[0,0] op_sel_hi:[1,0]
    v_pk_fma_f32 v[120:121], v[120:121], s[22:23], v[112:113] op_sel:[1,1,0] op_sel_hi:[0,1,1] neg_hi:[0,1,0]
    v_pk_add_f32 v[122:123], v[106:107], v[148:149] neg_lo:[0,1] neg_hi:[0,1]
    v_pk_add_f32 v[106:107], v[106:107], v[148:149]
    v_pk_add_f32 v[114:115], v[138:139], v[150:151] neg_lo:[0,1] neg_hi:[0,1]
    v_pk_add_f32 v[138:139], v[138:139], v[150:151]
    v_pk_mul_f32 v[126:127], v[114:115], s[22:23] op_sel:[0,0] op_sel_hi:[1,0]
    v_pk_fma_f32 v[114:115], v[114:115], s[22:23], v[126:127] op_sel:[1,1,0] op_sel_hi:[0,1,1] neg_hi:[0,1,0]
    v_pk_add_f32 v[118:119], v[104:105], v[106:107] neg_lo:[0,1] neg_hi:[0,1]
    v_pk_add_f32 v[104:105], v[104:105], v[106:107]
    v_pk_add_f32 v[106:107], v[136:137], v[138:139] neg_lo:[0,1] neg_hi:[0,1]
    v_pk_add_f32 v[136:137], v[136:137], v[138:139]
    v_pk_add_f32 v[138:139], v[104:105], v[136:137] neg_lo:[0,1] neg_hi:[0,1]
    v_pk_add_f32 v[104:105], v[104:105], v[136:137]
    v_pk_add_f32 v[136:137], v[118:119], v[106:107] op_sel:[0,1] op_sel_hi:[1,0] neg_lo:[0,1]
    v_pk_add_f32 v[118:119], v[118:119], v[106:107] op_sel:[0,1] op_sel_hi:[1,0] neg_hi:[0,1]
    v_pk_add_f32 v[108:109], v[142:143], v[122:123] op_sel:[0,1] op_sel_hi:[1,0] neg_hi:[0,1]
    v_pk_add_f32 v[142:143], v[142:143], v[122:123] op_sel:[0,1] op_sel_hi:[1,0] neg_lo:[0,1]
    v_pk_add_f32 v[122:123], v[120:121], v[114:115] op_sel:[0,1] op_sel_hi:[1,0] neg_hi:[0,1]
    v_pk_add_f32 v[120:121], v[120:121], v[114:115] op_sel:[0,1] op_sel_hi:[1,0] neg_lo:[0,1]
    v_pk_add_f32 v[114:115], v[142:143], v[120:121] neg_lo:[0,1] neg_hi:[0,1]
    v_pk_add_f32 v[142:143], v[142:143], v[120:121]
    v_pk_add_f32 v[120:121], v[108:109], v[122:123] op_sel:[0,1] op_sel_hi:[1,0] neg_lo:[0,1]
    v_pk_add_f32 v[108:109], v[108:109], v[122:123] op_sel:[0,1] op_sel_hi:[1,0] neg_hi:[0,1]
    ds_write_b64 v23, v[104:105] offset:0
    ds_write_b64 v23, v[142:143] offset:64
    ds_write_b64 v23, v[136:137] offset:128
    ds_write_b64 v23, v[120:121] offset:192
    ds_write_b64 v23, v[138:139] offset:256
    ds_write_b64 v23, v[114:115] offset:320
    ds_write_b64 v23, v[118:119] offset:384
    ds_write_b64 v23, v[108:109] offset:448
    s_waitcnt lgkmcnt(8)
    v_pk_mul_f32 v[110:111], v[130:131], v[58:59] op_sel:[0,0] op_sel_hi:[1,0]
    v_pk_fma_f32 v[130:131], v[130:131], v[58:59], v[110:111] op_sel:[1,1,0] op_sel_hi:[0,1,1] neg_hi:[0,1,0]
    v_pk_mul_f32 v[144:145], v[140:141], v[60:61] op_sel:[0,0] op_sel_hi:[1,0]
    v_pk_fma_f32 v[140:141], v[140:141], v[60:61], v[144:145] op_sel:[1,1,0] op_sel_hi:[0,1,1] neg_hi:[0,1,0]
    v_pk_mul_f32 v[112:113], v[132:133], v[62:63] op_sel:[0,0] op_sel_hi:[1,0]
    v_pk_fma_f32 v[132:133], v[132:133], v[62:63], v[112:113] op_sel:[1,1,0] op_sel_hi:[0,1,1] neg_hi:[0,1,0]
    v_pk_mul_f32 v[148:149], v[134:135], v[64:65] op_sel:[0,0] op_sel_hi:[1,0]
    v_pk_fma_f32 v[134:135], v[134:135], v[64:65], v[148:149] op_sel:[1,1,0] op_sel_hi:[0,1,1] neg_hi:[0,1,0]
    v_pk_mul_f32 v[150:151], v[146:147], v[66:67] op_sel:[0,0] op_sel_hi:[1,0]
    v_pk_fma_f32 v[146:147], v[146:147], v[66:67], v[150:151] op_sel:[1,1,0] op_sel_hi:[0,1,1] neg_hi:[0,1,0]
    v_pk_mul_f32 v[126:127], v[124:125], v[68:69] op_sel:[0,0] op_sel_hi:[1,0]
    v_pk_fma_f32 v[124:125], v[124:125], v[68:69], v[126:127] op_sel:[1,1,0] op_sel_hi:[0,1,1] neg_hi:[0,1,0]
    v_pk_mul_f32 v[106:107], v[116:117], v[70:71] op_sel:[0,0] op_sel_hi:[1,0]
    v_pk_fma_f32 v[116:117], v[116:117], v[70:71], v[106:107] op_sel:[1,1,0] op_sel_hi:[0,1,1] neg_hi:[0,1,0]
    v_pk_add_f32 v[122:123], v[128:129], v[134:135] neg_lo:[0,1] neg_hi:[0,1]
    v_pk_add_f32 v[128:129], v[128:129], v[134:135]
    v_pk_add_f32 v[104:105], v[130:131], v[146:147] neg_lo:[0,1] neg_hi:[0,1]
    v_pk_add_f32 v[130:131], v[130:131], v[146:147]
    v_pk_mul_f32 v[142:143], v[104:105], s[22:23] op_sel:[0,0] op_sel_hi:[1,0]
    v_pk_fma_f32 v[104:105], v[104:105], s[22:23], v[142:143] op_sel:[1,1,0] op_sel_hi:[0,1,1] neg_hi:[0,1,0]
    v_pk_add_f32 v[136:137], v[140:141], v[124:125] neg_lo:[0,1] neg_hi:[0,1]
    v_pk_add_f32 v[140:141], v[140:141], v[124:125]
    v_pk_add_f32 v[120:121], v[132:133], v[116:117] neg_lo:[0,1] neg_hi:[0,1]
    v_pk_add_f32 v[132:133], v[132:133], v[116:117]
    v_pk_mul_f32 v[138:139], v[120:121], s[22:23] op_sel:[0,0] op_sel_hi:[1,0]
    v_pk_fma_f32 v[120:121], v[120:121], s[22:23], v[138:139] op_sel:[1,1,0] op_sel_hi:[0,1,1] neg_hi:[0,1,0]
    v_pk_add_f32 v[114:115], v[128:129], v[140:141] neg_lo:[0,1] neg_hi:[0,1]
    v_pk_add_f32 v[128:129], v[128:129], v[140:141]
    v_pk_add_f32 v[140:141], v[130:131], v[132:133] neg_lo:[0,1] neg_hi:[0,1]
    v_pk_add_f32 v[130:131], v[130:131], v[132:133]
    v_pk_add_f32 v[132:133], v[128:129], v[130:131] neg_lo:[0,1] neg_hi:[0,1]
    v_pk_add_f32 v[128:129], v[128:129], v[130:131]
    v_pk_add_f32 v[130:131], v[114:115], v[140:141] op_sel:[0,1] op_sel_hi:[1,0] neg_lo:[0,1]
    v_pk_add_f32 v[114:115], v[114:115], v[140:141] op_sel:[0,1] op_sel_hi:[1,0] neg_hi:[0,1]
    v_pk_add_f32 v[118:119], v[122:123], v[136:137] op_sel:[0,1] op_sel_hi:[1,0] neg_hi:[0,1]
    v_pk_add_f32 v[122:123], v[122:123], v[136:137] op_sel:[0,1] op_sel_hi:[1,0] neg_lo:[0,1]
    v_pk_add_f32 v[136:137], v[104:105], v[120:121] op_sel:[0,1] op_sel_hi:[1,0] neg_hi:[0,1]
    v_pk_add_f32 v[104:105], v[104:105], v[120:121] op_sel:[0,1] op_sel_hi:[1,0] neg_lo:[0,1]
    v_pk_add_f32 v[120:121], v[122:123], v[104:105] neg_lo:[0,1] neg_hi:[0,1]
    v_pk_add_f32 v[122:123], v[122:123], v[104:105]
    v_pk_add_f32 v[104:105], v[118:119], v[136:137] op_sel:[0,1] op_sel_hi:[1,0] neg_lo:[0,1]
    v_pk_add_f32 v[118:119], v[118:119], v[136:137] op_sel:[0,1] op_sel_hi:[1,0] neg_hi:[0,1]
    ds_write_b64 v27, v[128:129] offset:0
    ds_write_b64 v27, v[122:123] offset:64
    ds_write_b64 v27, v[130:131] offset:128
    ds_write_b64 v27, v[104:105] offset:192
    ds_write_b64 v27, v[132:133] offset:256
    ds_write_b64 v27, v[120:121] offset:320
    ds_write_b64 v27, v[114:115] offset:384
    ds_write_b64 v27, v[118:119] offset:448
    ds_read_b64 v[108:109], v22 offset:0
    ds_read_b64 v[110:111], v22 offset:576
    ds_read_b64 v[144:145], v22 offset:1152
    ds_read_b64 v[112:113], v22 offset:1728
    ds_read_b64 v[148:149], v22 offset:2304
    ds_read_b64 v[150:151], v22 offset:2880
    ds_read_b64 v[126:127], v22 offset:3456
    ds_read_b64 v[106:107], v22 offset:4032
    ds_read_b64 v[134:135], v26 offset:0
    ds_read_b64 v[146:147], v26 offset:576
    ds_read_b64 v[142:143], v26 offset:1152
    ds_read_b64 v[124:125], v26 offset:1728
    ds_read_b64 v[116:117], v26 offset:2304
    ds_read_b64 v[138:139], v26 offset:2880
    ds_read_b64 v[140:141], v26 offset:3456
    ds_read_b64 v[136:137], v26 offset:4032
    s_lshl_b32 s16, s2, 3
    s_lshl_b32 s17, s30, 1
    s_add_u32 s17, s17, s16
    s_lshl_b32 s17, s17, 12
    s_add_u32 s18, s17, 4096
    v_lshlrev_b32 v7, 2, v6
    s_waitcnt lgkmcnt(8)
    v_pk_mul_f32 v[128:129], v[110:111], v[42:43] op_sel:[0,0] op_sel_hi:[1,0]
    v_pk_fma_f32 v[110:111], v[110:111], v[42:43], v[128:129] op_sel:[1,1,0] op_sel_hi:[0,1,1] neg_hi:[0,1,0]
    v_pk_mul_f32 v[122:123], v[144:145], v[44:45] op_sel:[0,0] op_sel_hi:[1,0]
    v_pk_fma_f32 v[144:145], v[144:145], v[44:45], v[122:123] op_sel:[1,1,0] op_sel_hi:[0,1,1] neg_hi:[0,1,0]
    v_pk_mul_f32 v[130:131], v[112:113], v[46:47] op_sel:[0,0] op_sel_hi:[1,0]
    v_pk_fma_f32 v[112:113], v[112:113], v[46:47], v[130:131] op_sel:[1,1,0] op_sel_hi:[0,1,1] neg_hi:[0,1,0]
    v_pk_mul_f32 v[104:105], v[148:149], v[48:49] op_sel:[0,0] op_sel_hi:[1,0]
    v_pk_fma_f32 v[148:149], v[148:149], v[48:49], v[104:105] op_sel:[1,1,0] op_sel_hi:[0,1,1] neg_hi:[0,1,0]
    v_pk_mul_f32 v[132:133], v[150:151], v[50:51] op_sel:[0,0] op_sel_hi:[1,0]
    v_pk_fma_f32 v[150:151], v[150:151], v[50:51], v[132:133] op_sel:[1,1,0] op_sel_hi:[0,1,1] neg_hi:[0,1,0]
    v_pk_mul_f32 v[120:121], v[126:127], v[52:53] op_sel:[0,0] op_sel_hi:[1,0]
    v_pk_fma_f32 v[126:127], v[126:127], v[52:53], v[120:121] op_sel:[1,1,0] op_sel_hi:[0,1,1] neg_hi:[0,1,0]
    v_pk_mul_f32 v[114:115], v[106:107], v[54:55] op_sel:[0,0] op_sel_hi:[1,0]
    v_pk_fma_f32 v[106:107], v[106:107], v[54:55], v[114:115] op_sel:[1,1,0] op_sel_hi:[0,1,1] neg_hi:[0,1,0]
    v_pk_add_f32 v[118:119], v[108:109], v[148:149] neg_lo:[0,1] neg_hi:[0,1]
    v_pk_add_f32 v[108:109], v[108:109], v[148:149]
    v_pk_add_f32 v[128:129], v[110:111], v[150:151] neg_lo:[0,1] neg_hi:[0,1]
    v_pk_add_f32 v[110:111], v[110:111], v[150:151]
    v_pk_mul_f32 v[122:123], v[128:129], s[22:23] op_sel:[0,0] op_sel_hi:[1,0]
    v_pk_fma_f32 v[128:129], v[128:129], s[22:23], v[122:123] op_sel:[1,1,0] op_sel_hi:[0,1,1] neg_hi:[0,1,0]
    v_pk_add_f32 v[130:131], v[144:145], v[126:127] neg_lo:[0,1] neg_hi:[0,1]
    v_pk_add_f32 v[144:145], v[144:145], v[126:127]
    v_pk_add_f32 v[104:105], v[112:113], v[106:107] neg_lo:[0,1] neg_hi:[0,1]
    v_pk_add_f32 v[112:113], v[112:113], v[106:107]
    v_pk_mul_f32 v[132:133], v[104:105], s[22:23] op_sel:[0,0] op_sel_hi:[1,0]
    v_pk_fma_f32 v[104:105], v[104:105], s[22:23], v[132:133] op_sel:[1,1,0] op_sel_hi:[0,1,1] neg_hi:[0,1,0]
    v_pk_add_f32 v[120:121], v[108:109], v[144:145] neg_lo:[0,1] neg_hi:[0,1]
    v_pk_add_f32 v[108:109], v[108:109], v[144:145]
    v_pk_add_f32 v[144:145], v[110:111], v[112:113] neg_lo:[0,1] neg_hi:[0,1]
    v_pk_add_f32 v[110:111], v[110:111], v[112:113]
    v_pk_add_f32 v[112:113], v[108:109], v[110:111] neg_lo:[0,1] neg_hi:[0,1]
    v_pk_add_f32 v[108:109], v[108:109], v[110:111]
    v_pk_add_f32 v[110:111], v[120:121], v[144:145] op_sel:[0,1] op_sel_hi:[1,0] neg_lo:[0,1]
    v_pk_add_f32 v[120:121], v[120:121], v[144:145] op_sel:[0,1] op_sel_hi:[1,0] neg_hi:[0,1]
    v_pk_add_f32 v[114:115], v[118:119], v[130:131] op_sel:[0,1] op_sel_hi:[1,0] neg_hi:[0,1]
    v_pk_add_f32 v[118:119], v[118:119], v[130:131] op_sel:[0,1] op_sel_hi:[1,0] neg_lo:[0,1]
    v_pk_add_f32 v[130:131], v[128:129], v[104:105] op_sel:[0,1] op_sel_hi:[1,0] neg_hi:[0,1]
    v_pk_add_f32 v[128:129], v[128:129], v[104:105] op_sel:[0,1] op_sel_hi:[1,0] neg_lo:[0,1]
    v_pk_add_f32 v[104:105], v[118:119], v[128:129] neg_lo:[0,1] neg_hi:[0,1]
    v_pk_add_f32 v[118:119], v[118:119], v[128:129]
    v_pk_add_f32 v[128:129], v[114:115], v[130:131] op_sel:[0,1] op_sel_hi:[1,0] neg_lo:[0,1]
    v_pk_add_f32 v[114:115], v[114:115], v[130:131] op_sel:[0,1] op_sel_hi:[1,0] neg_hi:[0,1]
    v_cvt_pk_bf16_f32 v108, v108, v109
    buffer_store_dword v108, v7, s[8:11], s17 offen offset:0 sc1
    v_cvt_pk_bf16_f32 v118, v118, v119
    buffer_store_dword v118, v7, s[8:11], s17 offen offset:256 sc1
    v_cvt_pk_bf16_f32 v110, v110, v111
    buffer_store_dword v110, v7, s[8:11], s17 offen offset:512 sc1
    v_cvt_pk_bf16_f32 v128, v128, v129
    buffer_store_dword v128, v7, s[8:11], s17 offen offset:768 sc1
    v_cvt_pk_bf16_f32 v112, v112, v113
    buffer_store_dword v112, v7, s[8:11], s17 offen offset:1024 sc1
    v_cvt_pk_bf16_f32 v104, v104, v105
    buffer_store_dword v104, v7, s[8:11], s17 offen offset:1280 sc1
    v_cvt_pk_bf16_f32 v120, v120, v121
    buffer_store_dword v120, v7, s[8:11], s17 offen offset:1536 sc1
    v_cvt_pk_bf16_f32 v114, v114, v115
    buffer_store_dword v114, v7, s[8:11], s17 offen offset:1792 sc1
    s_waitcnt lgkmcnt(0)
    v_pk_mul_f32 v[148:149], v[146:147], v[42:43] op_sel:[0,0] op_sel_hi:[1,0]
    v_pk_fma_f32 v[146:147], v[146:147], v[42:43], v[148:149] op_sel:[1,1,0] op_sel_hi:[0,1,1] neg_hi:[0,1,0]
    v_pk_mul_f32 v[150:151], v[142:143], v[44:45] op_sel:[0,0] op_sel_hi:[1,0]
    v_pk_fma_f32 v[142:143], v[142:143], v[44:45], v[150:151] op_sel:[1,1,0] op_sel_hi:[0,1,1] neg_hi:[0,1,0]
    v_pk_mul_f32 v[122:123], v[124:125], v[46:47] op_sel:[0,0] op_sel_hi:[1,0]
    v_pk_fma_f32 v[124:125], v[124:125], v[46:47], v[122:123] op_sel:[1,1,0] op_sel_hi:[0,1,1] neg_hi:[0,1,0]
    v_pk_mul_f32 v[126:127], v[116:117], v[48:49] op_sel:[0,0] op_sel_hi:[1,0]
    v_pk_fma_f32 v[116:117], v[116:117], v[48:49], v[126:127] op_sel:[1,1,0] op_sel_hi:[0,1,1] neg_hi:[0,1,0]
    v_pk_mul_f32 v[106:107], v[138:139], v[50:51] op_sel:[0,0] op_sel_hi:[1,0]
    v_pk_fma_f32 v[138:139], v[138:139], v[50:51], v[106:107] op_sel:[1,1,0] op_sel_hi:[0,1,1] neg_hi:[0,1,0]
    v_pk_mul_f32 v[132:133], v[140:141], v[52:53] op_sel:[0,0] op_sel_hi:[1,0]
    v_pk_fma_f32 v[140:141], v[140:141], v[52:53], v[132:133] op_sel:[1,1,0] op_sel_hi:[0,1,1] neg_hi:[0,1,0]
    v_pk_mul_f32 v[144:145], v[136:137], v[54:55] op_sel:[0,0] op_sel_hi:[1,0]
    v_pk_fma_f32 v[136:137], v[136:137], v[54:55], v[144:145] op_sel:[1,1,0] op_sel_hi:[0,1,1] neg_hi:[0,1,0]
    v_pk_add_f32 v[130:131], v[134:135], v[116:117] neg_lo:[0,1] neg_hi:[0,1]
    v_pk_add_f32 v[134:135], v[134:135], v[116:117]
    v_pk_add_f32 v[148:149], v[146:147], v[138:139] neg_lo:[0,1] neg_hi:[0,1]
    v_pk_add_f32 v[146:147], v[146:147], v[138:139]
    v_pk_mul_f32 v[150:151], v[148:149], s[22:23] op_sel:[0,0] op_sel_hi:[1,0]
    v_pk_fma_f32 v[148:149], v[148:149], s[22:23], v[150:151] op_sel:[1,1,0] op_sel_hi:[0,1,1] neg_hi:[0,1,0]
    v_pk_add_f32 v[122:123], v[142:143], v[140:141] neg_lo:[0,1] neg_hi:[0,1]
    v_pk_add_f32 v[142:143], v[142:143], v[140:141]
    v_pk_add_f32 v[126:127], v[124:125], v[136:137] neg_lo:[0,1] neg_hi:[0,1]
    v_pk_add_f32 v[124:125], v[124:125], v[136:137]
    v_pk_mul_f32 v[106:107], v[126:127], s[22:23] op_sel:[0,0] op_sel_hi:[1,0]
    v_pk_fma_f32 v[126:127], v[126:127], s[22:23], v[106:107] op_sel:[1,1,0] op_sel_hi:[0,1,1] neg_hi:[0,1,0]
    v_pk_add_f32 v[132:133], v[134:135], v[142:143] neg_lo:[0,1] neg_hi:[0,1]
    v_pk_add_f32 v[134:135], v[134:135], v[142:143]
    v_pk_add_f32 v[142:143], v[146:147], v[124:125] neg_lo:[0,1] neg_hi:[0,1]
    v_pk_add_f32 v[146:147], v[146:147], v[124:125]
    v_pk_add_f32 v[124:125], v[134:135], v[146:147] neg_lo:[0,1] neg_hi:[0,1]
    v_pk_add_f32 v[134:135], v[134:135], v[146:147]
    v_pk_add_f32 v[146:147], v[132:133], v[142:143] op_sel:[0,1] op_sel_hi:[1,0] neg_lo:[0,1]
    v_pk_add_f32 v[132:133], v[132:133], v[142:143] op_sel:[0,1] op_sel_hi:[1,0] neg_hi:[0,1]
    v_pk_add_f32 v[144:145], v[130:131], v[122:123] op_sel:[0,1] op_sel_hi:[1,0] neg_hi:[0,1]
    v_pk_add_f32 v[130:131], v[130:131], v[122:123] op_sel:[0,1] op_sel_hi:[1,0] neg_lo:[0,1]
    v_pk_add_f32 v[122:123], v[148:149], v[126:127] op_sel:[0,1] op_sel_hi:[1,0] neg_hi:[0,1]
    v_pk_add_f32 v[148:149], v[148:149], v[126:127] op_sel:[0,1] op_sel_hi:[1,0] neg_lo:[0,1]
    v_pk_add_f32 v[126:127], v[130:131], v[148:149] neg_lo:[0,1] neg_hi:[0,1]
    v_pk_add_f32 v[130:131], v[130:131], v[148:149]
    v_pk_add_f32 v[148:149], v[144:145], v[122:123] op_sel:[0,1] op_sel_hi:[1,0] neg_lo:[0,1]
    v_pk_add_f32 v[144:145], v[144:145], v[122:123] op_sel:[0,1] op_sel_hi:[1,0] neg_hi:[0,1]
    v_cvt_pk_bf16_f32 v134, v134, v135
    buffer_store_dword v134, v7, s[8:11], s18 offen offset:0 sc1
    v_cvt_pk_bf16_f32 v130, v130, v131
    buffer_store_dword v130, v7, s[8:11], s18 offen offset:256 sc1
    v_cvt_pk_bf16_f32 v146, v146, v147
    buffer_store_dword v146, v7, s[8:11], s18 offen offset:512 sc1
    v_cvt_pk_bf16_f32 v148, v148, v149
    buffer_store_dword v148, v7, s[8:11], s18 offen offset:768 sc1
    v_cvt_pk_bf16_f32 v124, v124, v125
    buffer_store_dword v124, v7, s[8:11], s18 offen offset:1024 sc1
    v_cvt_pk_bf16_f32 v126, v126, v127
    buffer_store_dword v126, v7, s[8:11], s18 offen offset:1280 sc1
    v_cvt_pk_bf16_f32 v132, v132, v133
    buffer_store_dword v132, v7, s[8:11], s18 offen offset:1536 sc1
    v_cvt_pk_bf16_f32 v144, v144, v145
    buffer_store_dword v144, v7, s[8:11], s18 offen offset:1792 sc1
    s_endpgm
.p2align 6
L_k3_kernel_r1:
    s_mov_b32 s57, 76021760
    s_load_dwordx2 s[4:5], s[0:1], 80
    s_load_dwordx2 s[28:29], s[0:1], 96
    s_and_b32 s16, s2, 15
    s_lshr_b32 s17, s2, 4
    v_and_b32 v6, 15, v0
    v_lshrrev_b32 v7, 4, v0
    v_lshlrev_b32 v9, 12, v7
    v_lshl_add_u32 v9, v6, 4, v9
    s_lshl_b32 s18, s17, 18
    s_lshl_b32 s19, s16, 8
    s_add_u32 s18, s18, s19
    s_add_u32 s18, s18, 58720256
    s_waitcnt lgkmcnt(0)
    s_mov_b32 s8, s4
    s_mov_b32 s9, s5
    s_mov_b32 s10, 8388608
    s_mov_b32 s11, 0x00020000
    s_mov_b32 s32, s28
    s_mov_b32 s33, s29
    s_mov_b32 s34, 268435456
    s_mov_b32 s35, 0x00020000
    buffer_load_dwordx4 v[16:19], v9, s[32:35], s18 offen
    s_add_u32 s18, s18, 65536
    buffer_load_dwordx4 v[20:23], v9, s[32:35], s18 offen
    s_add_u32 s18, s18, 65536
    buffer_load_dwordx4 v[24:27], v9, s[32:35], s18 offen
    s_add_u32 s18, s18, 65536
    buffer_load_dwordx4 v[28:31], v9, s[32:35], s18 offen
    v_lshlrev_b32 v4, 8, v7
    v_lshrrev_b32 v5, 3, v7
    v_lshl_add_u32 v4, v5, 4, v4
    v_lshl_add_u32 v4, v6, 4, v4
    s_waitcnt vmcnt(3)
    ds_write_b128 v4, v[16:19] offset:0
    s_waitcnt vmcnt(2)
    ds_write_b128 v4, v[20:23] offset:4128
    s_waitcnt vmcnt(1)
    ds_write_b128 v4, v[24:27] offset:8256
    s_waitcnt vmcnt(0)
    ds_write_b128 v4, v[28:31] offset:12384
    v_and_b32 v2, 7, v0
    v_lshrrev_b32 v1, 3, v0
    v_mul_u32_u24 v8, 2064, v2
    v_lshl_add_u32 v8, v1, 1, v8
    s_waitcnt lgkmcnt(0)
    s_barrier
    ds_read_u16_d16 v32, v8 offset:0
    ds_read_u16_d16_hi v48, v8 offset:256
    ds_read_u16_d16 v33, v8 offset:512
    ds_read_u16_d16_hi v49, v8 offset:768
    ds_read_u16_d16 v34, v8 offset:1024
    ds_read_u16_d16_hi v50, v8 offset:1280
    ds_read_u16_d16 v35, v8 offset:1536
    ds_read_u16_d16_hi v51, v8 offset:1792
    ds_read_u16_d16 v36, v8 offset:64
    ds_read_u16_d16_hi v52, v8 offset:320
    ds_read_u16_d16 v37, v8 offset:576
    ds_read_u16_d16_hi v53, v8 offset:832
    ds_read_u16_d16 v38, v8 offset:1088
    ds_read_u16_d16_hi v54, v8 offset:1344
    ds_read_u16_d16 v39, v8 offset:1600
    ds_read_u16_d16_hi v55, v8 offset:1856
    ds_read_u16_d16 v40, v8 offset:128
    ds_read_u16_d16_hi v56, v8 offset:384
    ds_read_u16_d16 v41, v8 offset:640
    ds_read_u16_d16_hi v57, v8 offset:896
    ds_read_u16_d16 v42, v8 offset:1152
    ds_read_u16_d16_hi v58, v8 offset:1408
    ds_read_u16_d16 v43, v8 offset:1664
    ds_read_u16_d16_hi v59, v8 offset:1920
    ds_read_u16_d16 v44, v8 offset:192
    ds_read_u16_d16_hi v60, v8 offset:448
    ds_read_u16_d16 v45, v8 offset:704
    ds_read_u16_d16_hi v61, v8 offset:960
    ds_read_u16_d16 v46, v8 offset:1216
    ds_read_u16_d16_hi v62, v8 offset:1472
    ds_read_u16_d16 v47, v8 offset:1728
    ds_read_u16_d16_hi v63, v8 offset:1984
    v_lshlrev_b32 v3, 12, v1
    v_lshl_add_u32 v3, v2, 4, v3
    s_lshl_b32 s18, s16, 19
    s_lshl_b32 s19, s17, 7
    s_add_u32 s18, s18, s19
    s_add_u32 s18, s18, 2048
    s_waitcnt lgkmcnt(15)
    v_or_b32 v32, v32, v48
    v_or_b32 v33, v33, v49
    v_or_b32 v34, v34, v50
    v_or_b32 v35, v35, v51
    buffer_store_dwordx4 v[32:35], v3, s[8:11], s18 offen sc1
    s_add_u32 s18, s18, 131072
    s_waitcnt lgkmcnt(15)
    v_or_b32 v36, v36, v52
    v_or_b32 v37, v37, v53
    v_or_b32 v38, v38, v54
    v_or_b32 v39, v39, v55
    buffer_store_dwordx4 v[36:39], v3, s[8:11], s18 offen sc1
    s_add_u32 s18, s18, 131072
    s_waitcnt lgkmcnt(8)
    v_or_b32 v40, v40, v56
    v_or_b32 v41, v41, v57
    v_or_b32 v42, v42, v58
    v_or_b32 v43, v43, v59
    buffer_store_dwordx4 v[40:43], v3, s[8:11], s18 offen sc1
    s_add_u32 s18, s18, 131072
    s_waitcnt lgkmcnt(0)
    v_or_b32 v44, v44, v60
    v_or_b32 v45, v45, v61
    v_or_b32 v46, v46, v62
    v_or_b32 v47, v47, v63
    buffer_store_dwordx4 v[44:47], v3, s[8:11], s18 offen sc1
    s_endpgm
.section .rodata,"a"
.p2align 6
.amdhsa_kernel k1_kernel
  .amdhsa_next_free_vgpr 96
  .amdhsa_next_free_sgpr 96
  .amdhsa_accum_offset 96
  .amdhsa_group_segment_fixed_size 0
  .amdhsa_kernarg_size 104
  .amdhsa_user_sgpr_count 2
  .amdhsa_user_sgpr_kernarg_segment_ptr 1
  .amdhsa_system_sgpr_workgroup_id_x 1
.end_amdhsa_kernel
.p2align 6
.amdhsa_kernel k2_kernel
  .amdhsa_next_free_vgpr 156
  .amdhsa_next_free_sgpr 96
  .amdhsa_accum_offset 156
  .amdhsa_group_segment_fixed_size 0
  .amdhsa_kernarg_size 104
  .amdhsa_user_sgpr_count 2
  .amdhsa_user_sgpr_kernarg_segment_ptr 1
  .amdhsa_system_sgpr_workgroup_id_x 1
.end_amdhsa_kernel
.p2align 6
.amdhsa_kernel k3_kernel
  .amdhsa_next_free_vgpr 152
  .amdhsa_next_free_sgpr 96
  .amdhsa_accum_offset 152
  .amdhsa_group_segment_fixed_size 0
  .amdhsa_kernarg_size 104
  .amdhsa_user_sgpr_count 2
  .amdhsa_user_sgpr_kernarg_segment_ptr 1
  .amdhsa_system_sgpr_workgroup_id_x 1
.end_amdhsa_kernel
```
